```python
import torch

def _softmax(x, axis=-1):
    return torch.softmax(x, dim=axis)
def _gelu(x):
    return torch.nn.functional.gelu(x, approximate="tanh")
def _silu(x):
    return torch.nn.functional.silu(x)
def _sigmoid(x):
    return torch.sigmoid(x)
def _layernorm(x, axis=-1, eps=1e-5):
    m = x.mean(dim=axis, keepdim=True)
    v = x.var(dim=axis, keepdim=True, unbiased=False)
    return (x - m) / torch.sqrt(v + eps)
def _scatter_add(tgt, idx, src, axis=0):
    return tgt.clone().index_add_(axis, idx, src)
def _segment_sum(src, seg, n):
    out = torch.zeros((n,) + src.shape[1:], dtype=src.dtype)
    return out.index_add_(0, seg, src)
def _pad(x, pw):
    flat = tuple(v for pair in reversed(pw) for v in pair)
    return torch.nn.functional.pad(x, flat)

kernel_name = 'standalone__edge_featured_mpnn_gatedgcn__graph'

def setup_inputs():

    _w = (lambda a: (lambda t: t.to(torch.bfloat16) if t.is_floating_point() else t)(torch.as_tensor(a)))
    N, deg, D, De = 10000, 64, 64, max(0, 1)
    E = N * deg
    return {
        "x": _w((lambda *s: torch.randn(*s, dtype=torch.bfloat16) * 0.8)(N, D)),
        "e_attr": _w((lambda *s: torch.randn(*s, dtype=torch.bfloat16) * 1.6)(E, De)),
        "src": _w((lambda lo, hi, *s: torch.randint(lo, hi, s))(0, N, E).to(torch.int64)),
        "dst": _w((lambda lo, hi, *s: torch.randint(lo, hi, s))(0, N, E).to(torch.int64)),
        "w_a": _w((lambda *s: torch.randn(*s, dtype=torch.bfloat16) * 0.8)(D, D)),
        "w_b": _w((lambda *s: torch.randn(*s, dtype=torch.bfloat16) * 0.8)(D, D)),
        "w_c": _w((lambda *s: torch.randn(*s, dtype=torch.bfloat16) * 1.6)(De, D)),
        "w_u": _w((lambda *s: torch.randn(*s, dtype=torch.bfloat16) * 0.05)(D, D)),
        "w_v": _w((lambda *s: torch.randn(*s, dtype=torch.bfloat16) * 0.05)(D, D)),
    }

def reference(x, e_attr, src, dst, w_a, w_b, w_c, w_u, w_v):
    N, D = x.shape
    hv = x @ w_v
    g = x[dst] @ w_a + x[src] @ w_b + e_attr @ w_c
    eta = _sigmoid(g)
    denom = _segment_sum(eta, dst, N) + 1e-6
    eta_n = eta / denom[dst]
    agg = _segment_sum(eta_n * hv[src], dst, N)
    z = x @ w_u + agg
    relu_z = torch.where(z > 0, z, 0 * z)
    return x + relu_z
```

```asm
; @launch kernel=k1_kernel grid=(256,1,1) block=(1024,1,1) lds=31744
; @launch kernel=k2_kernel grid=(256,1,1) block=(1024,1,1) lds=94976
.amdgcn_target "amdgcn-amd-amdhsa--gfx950"
.text
.globl k1_kernel
.p2align 8
.type k1_kernel,@function
k1_kernel:
    s_cmp_ge_u32 s2, 256
    s_cbranch_scc1 K1_END
    s_getpc_b64 s[30:31]
K1_PC:
    v_lshlrev_b32 v90, 7, v0
    v_cmp_gt_u32 vcc, CODE_END-K1_PC, v90
    s_and_saveexec_b64 s[28:29], vcc
    s_cbranch_execz K1_NOCPF
    global_load_dword v91, v90, s[30:31]
K1_NOCPF:
    s_mov_b64 exec, s[28:29]
    s_and_b32 s20, s2, 7
    s_lshr_b32 s21, s2, 3
    s_lshl_b32 s20, s20, 5
    s_add_u32 s2, s20, s21
    v_lshrrev_b32 v1, 6, v0
    s_load_dwordx4 s[8:11], s[0:1], 16
    v_readfirstlane_b32 s20, v1
    s_load_dwordx2 s[4:5], s[0:1], 8
    s_load_dwordx2 s[6:7], s[0:1], 88
    v_and_b32 v2, 63, v0
    s_cmp_lt_u32 s20, 6
    s_cbranch_scc1 K1_TABLE
    v_subrev_u32 v0, 384, v0
    s_sub_u32 s20, s20, 6
    v_mov_b32 v5, 0
    v_lshlrev_b32 v6, 2, v0
    v_cmp_gt_u32 vcc, 256, v0
    s_and_saveexec_b64 s[30:31], vcc
    ds_write_b32 v6, v5 offset:0
    s_mov_b64 exec, s[30:31]
    v_lshlrev_b32 v3, 4, v0
    v_lshlrev_b32 v4, 3, v0
    s_mul_i32 s21, s2, 10000
    s_mul_i32 s22, s2, 5000
    s_mov_b32 s23, 109951163
    v_mov_b32 v19, 625
    v_cmp_gt_u32 s[46:47], v19, v0
    s_waitcnt lgkmcnt(0)
    s_mov_b32 s12, s10
    s_mov_b32 s13, s11
    s_mov_b32 s14, 2560000
    s_mov_b32 s15, 0x00020000
    buffer_load_dwordx4 v[8:11], v3, s[12:15], s21 offen
    s_mov_b32 s16, s8
    s_mov_b32 s17, s9
    s_mov_b32 s18, 2560000
    s_mov_b32 s19, 0x00020000
    buffer_load_dwordx4 v[12:15], v3, s[16:19], s21 offen
    s_mov_b32 s24, s4
    s_mov_b32 s25, s5
    s_mov_b32 s26, 1280000
    s_mov_b32 s27, 0x00020000
    buffer_load_dwordx2 v[16:17], v4, s[24:27], s22 offen
    s_mov_b32 s32, s6
    s_mov_b32 s33, s7
    s_mov_b32 s34, 3200000
    s_mov_b32 s35, 0x00020000
    s_add_u32 s36, s6, 3407872
    s_addc_u32 s37, s7, 0
    s_mov_b32 s38, 262144
    s_mov_b32 s39, 0x00020000
    v_lshlrev_b32 v6, 4, v2
    v_mul_u32_u24 v7, 20, v0
    v_lshlrev_b32 v18, 12, v2
    s_mul_i32 s25, s2, 12500
    s_lshl_b32 s26, s2, 2
    s_mov_b32 s40, 0x06050400
    s_mov_b32 s41, 0x05040003
    s_mov_b32 s42, 0x03020500
    s_mov_b32 s43, 0x04000302
    s_mov_b32 s44, 0x03060100
    s_mov_b32 s45, 0x07030201
    s_barrier
    v_mov_b32 v5, 1
    v_mov_b32 v19, 0
    s_waitcnt vmcnt(2)
    v_mul_hi_u32 v20, s23, v8
    v_mul_hi_u32 v21, s23, v9
    v_mul_hi_u32 v22, s23, v10
    v_mul_hi_u32 v23, s23, v11
    v_lshlrev_b32 v24, 2, v20
    v_lshlrev_b32 v25, 2, v21
    v_lshlrev_b32 v26, 2, v22
    v_lshlrev_b32 v27, 2, v23
    s_mov_b64 exec, s[46:47]
    ds_add_rtn_u32 v28, v24, v5 offset:0
    ds_add_rtn_u32 v29, v25, v5 offset:0
    ds_add_rtn_u32 v30, v26, v5 offset:0
    ds_add_rtn_u32 v31, v27, v5 offset:0
    s_mov_b64 exec, -1
    s_movk_i32 s27, 625
    v_mad_u32_u24 v20, v20, s27, 15
    v_mad_u32_u24 v21, v21, s27, 15
    v_mad_u32_u24 v22, v22, s27, 15
    v_mad_u32_u24 v23, v23, s27, 15
    v_lshrrev_b32 v20, 4, v20
    v_lshrrev_b32 v21, 4, v21
    v_lshrrev_b32 v22, 4, v22
    v_lshrrev_b32 v23, 4, v23
    v_sub_u32 v20, v8, v20
    v_sub_u32 v21, v9, v21
    v_sub_u32 v22, v10, v22
    v_sub_u32 v23, v11, v23
    v_lshlrev_b32 v20, 2, v20
    v_lshlrev_b32 v21, 2, v21
    v_lshlrev_b32 v22, 2, v22
    v_lshlrev_b32 v23, 2, v23
    s_waitcnt vmcnt(0)
    v_lshl_or_b32 v32, v16, 16, v12
    s_mov_b32 s24, 0xffff0000
    v_and_or_b32 v33, v16, s24, v13
    v_lshl_or_b32 v34, v17, 16, v14
    v_and_or_b32 v35, v17, s24, v15
    s_waitcnt lgkmcnt(0)
    s_waitcnt lgkmcnt(0)
    s_mov_b64 exec, 1
    ds_add_u32 v19, v5 offset:2052
    s_mov_b64 exec, -1
K1_SYNC2:
    ds_read_b32 v65, v19 offset:2052
    s_waitcnt lgkmcnt(0)
    v_readfirstlane_b32 s27, v65
    s_cmp_lt_u32 s27, 10
    s_cbranch_scc1 K1_SYNC2
    ds_read_b128 v[40:43], v6 offset:0
    s_waitcnt lgkmcnt(0)
    v_add_u32 v44, v40, v41
    v_add_u32 v45, v44, v42
    v_add_u32 v46, v45, v43
    v_mov_b32 v47, v46
    s_nop 1
    v_add_u32_dpp v47, v47, v47 row_shr:1 row_mask:0xf bank_mask:0xf
    s_nop 1
    v_add_u32_dpp v47, v47, v47 row_shr:2 row_mask:0xf bank_mask:0xf
    s_nop 1
    v_add_u32_dpp v47, v47, v47 row_shr:4 row_mask:0xf bank_mask:0xf
    s_nop 1
    v_add_u32_dpp v47, v47, v47 row_shr:8 row_mask:0xf bank_mask:0xf
    s_nop 1
    v_add_u32_dpp v47, v47, v47 row_bcast:15 row_mask:0xa bank_mask:0xf
    s_nop 1
    v_add_u32_dpp v47, v47, v47 row_bcast:31 row_mask:0xc bank_mask:0xf
    v_sub_u32 v48, v47, v46
    v_add_u32 v49, v48, v40
    v_add_u32 v50, v48, v44
    v_add_u32 v51, v48, v45
    ds_write_b128 v6, v[48:51] offset:1024
    s_waitcnt lgkmcnt(0)
    ds_read_b32 v56, v24 offset:1024
    ds_read_b32 v57, v25 offset:1024
    ds_read_b32 v58, v26 offset:1024
    ds_read_b32 v59, v27 offset:1024
    v_lshl_or_b32 v52, v40, 16, v48
    v_lshl_or_b32 v53, v41, 16, v49
    v_lshl_or_b32 v54, v42, 16, v50
    v_lshl_or_b32 v55, v43, 16, v51
    s_cmp_eq_u32 s20, 0
    s_cbranch_scc0 K1_DE0
    buffer_store_dword v52, v18, s[36:39], s26 offen offset:0
K1_DE0:
    s_cmp_eq_u32 s20, 1
    s_cbranch_scc0 K1_DE1
    buffer_store_dword v53, v18, s[36:39], s26 offen offset:1024
K1_DE1:
    s_cmp_eq_u32 s20, 2
    s_cbranch_scc0 K1_DE2
    buffer_store_dword v54, v18, s[36:39], s26 offen offset:2048
K1_DE2:
    s_cmp_eq_u32 s20, 3
    s_cbranch_scc0 K1_DE3
    buffer_store_dword v55, v18, s[36:39], s26 offen offset:3072
K1_DE3:
    s_waitcnt lgkmcnt(0)
    v_add_u32 v56, v56, v28
    v_add_u32 v57, v57, v29
    v_add_u32 v58, v58, v30
    v_add_u32 v59, v59, v31
    s_mov_b64 exec, s[46:47]
    ds_write_b8 v56, v20 offset:12544
    v_lshlrev_b32 v60, 2, v56
    ds_write_b8 v57, v21 offset:12544
    v_lshlrev_b32 v61, 2, v57
    ds_write_b8 v58, v22 offset:12544
    v_lshlrev_b32 v62, 2, v58
    ds_write_b8 v59, v23 offset:12544
    v_lshlrev_b32 v63, 2, v59
    ds_write_b32 v60, v32 offset:2304
    ds_write_b32 v61, v33 offset:2304
    ds_write_b32 v62, v34 offset:2304
    ds_write_b32 v63, v35 offset:2304
    s_mov_b64 exec, -1
    s_waitcnt lgkmcnt(0)
    s_waitcnt lgkmcnt(0)
    s_mov_b64 exec, 1
    ds_add_u32 v19, v5 offset:2056
    s_mov_b64 exec, -1
K1_SYNC3:
    ds_read_b32 v65, v19 offset:2056
    s_waitcnt lgkmcnt(0)
    v_readfirstlane_b32 s27, v65
    s_cmp_lt_u32 s27, 10
    s_cbranch_scc1 K1_SYNC3
    ds_read_b128 v[8:11], v3 offset:2304
    v_lshrrev_b32 v4, 2, v3
    ds_read_b32 v12, v4 offset:12544
    s_waitcnt lgkmcnt(0)
    v_perm_b32 v21, v9, v12, s40
    v_perm_b32 v22, v10, v9, s41
    v_perm_b32 v23, v11, v10, s43
    v_mov_b32 v20, v8
    v_perm_b32 v22, v12, v22, s42
    v_perm_b32 v23, v12, v23, s44
    v_perm_b32 v24, v12, v11, s45
    s_mov_b64 exec, s[46:47]
    buffer_store_dwordx4 v[20:23], v7, s[32:35], s25 offen sc0
    buffer_store_dword v24, v7, s[32:35], s25 offen offset:16 sc0
    s_mov_b64 exec, -1
    s_cmp_eq_u32 s20, 0
    s_cbranch_scc0 K1_SFIN
K1_SFIN:
    s_endpgm
K1_TABLE:
    s_load_dwordx2 s[40:41], s[0:1], 40
    s_load_dwordx2 s[42:43], s[0:1], 64
    s_load_dwordx2 s[44:45], s[0:1], 0
    s_mov_b32 s21, s20
    v_mov_b32 v5, 0
    v_lshlrev_b32 v6, 2, v2
    s_cmp_eq_u32 s21, 0
    s_cbranch_scc0 K1_T_NOZ
    v_cmp_gt_u32 vcc, 4, v2
    s_and_saveexec_b64 s[30:31], vcc
    ds_write_b32 v6, v5 offset:2048
    s_mov_b64 exec, s[30:31]
K1_T_NOZ:
    s_lshr_b32 s22, s21, 1
    s_lshl_b32 s22, s22, 4
    v_and_b32 v4, 15, v2
    v_add_u32 v4, s22, v4
    v_lshrrev_b32 v5, 4, v2
    v_lshlrev_b32 v6, 7, v4
    v_lshl_add_u32 v6, v5, 4, v6
    s_mul_i32 s58, s2, 625
    s_add_u32 s59, s58, 640
    s_add_u32 s58, s58, 15
    s_lshr_b32 s58, s58, 4
    s_lshr_b32 s59, s59, 4
    s_sub_u32 s59, s59, s58
    s_lshl_b32 s24, s58, 7
    v_lshlrev_b32 v7, 4, v2
    v_bfe_u32 v8, v2, 4, 1
    v_lshlrev_b32 v8, 1, v8
    v_and_b32 v9, 7, v2
    v_xor_b32 v8, v8, v9
    v_lshrrev_b32 v9, 3, v2
    v_lshlrev_b32 v9, 7, v9
    s_waitcnt lgkmcnt(0)
    s_add_u32 s26, s21, 0
    s_cmp_lt_u32 s26, 8
    s_cselect_b32 s48, s40, s42
    s_cselect_b32 s49, s41, s43
    s_mov_b32 s50, 8192
    s_mov_b32 s51, 0x00020000
    s_and_b32 s27, s26, 7
    s_lshl_b32 s27, s27, 10
    s_cmp_lt_u32 s26, 16
    s_cselect_b32 s27, s27, 1048576
    buffer_load_dwordx4 v[48:51], v7, s[48:51], s27 offen
    s_add_u32 s26, s21, 6
    s_cmp_lt_u32 s26, 8
    s_cselect_b32 s48, s40, s42
    s_cselect_b32 s49, s41, s43
    s_mov_b32 s50, 8192
    s_mov_b32 s51, 0x00020000
    s_and_b32 s27, s26, 7
    s_lshl_b32 s27, s27, 10
    s_cmp_lt_u32 s26, 16
    s_cselect_b32 s27, s27, 1048576
    buffer_load_dwordx4 v[52:55], v7, s[48:51], s27 offen
    s_add_u32 s26, s21, 12
    s_cmp_lt_u32 s26, 8
    s_cselect_b32 s48, s40, s42
    s_cselect_b32 s49, s41, s43
    s_mov_b32 s50, 8192
    s_mov_b32 s51, 0x00020000
    s_and_b32 s27, s26, 7
    s_lshl_b32 s27, s27, 10
    s_cmp_lt_u32 s26, 16
    s_cselect_b32 s27, s27, 1048576
    buffer_load_dwordx4 v[56:59], v7, s[48:51], s27 offen
    s_barrier
    s_mov_b32 s36, s44
    s_mov_b32 s37, s45
    s_mov_b32 s38, 1280000
    s_mov_b32 s39, 0x00020000
    buffer_load_dwordx4 v[24:27], v6, s[36:39], s24 offen
    buffer_load_dwordx4 v[28:31], v6, s[36:39], s24 offen offset:64
    s_add_u32 s44, s6, 4194304
    s_addc_u32 s45, s7, 0
    s_mov_b32 s46, 2560256
    s_mov_b32 s47, 0x00020000
    s_add_u32 s26, s21, 0
    s_and_b32 s27, s26, 1
    s_lshl_b32 s27, s27, 2
    v_xor_b32 v18, s27, v8
    v_lshl_add_u32 v18, v18, 4, v9
    s_lshl_b32 s27, s26, 10
    v_add_u32 v18, s27, v18
    s_add_u32 s26, s21, 6
    s_and_b32 s27, s26, 1
    s_lshl_b32 s27, s27, 2
    v_xor_b32 v19, s27, v8
    v_lshl_add_u32 v19, v19, 4, v9
    s_lshl_b32 s27, s26, 10
    v_add_u32 v19, s27, v19
    s_add_u32 s26, s21, 12
    s_and_b32 s27, s26, 1
    s_lshl_b32 s27, s27, 2
    v_xor_b32 v20, s27, v8
    v_lshl_add_u32 v20, v20, 4, v9
    s_lshl_b32 s27, s26, 10
    v_add_u32 v20, s27, v20
    s_and_b32 s23, s21, 1
    v_bfe_u32 v12, v2, 2, 2
    v_lshl_add_u32 v13, v5, 3, v12
    v_lshlrev_b32 v13, 7, v13
    v_and_b32 v14, 1, v2
    v_lshl_add_u32 v13, v14, 3, v13
    v_bfe_u32 v14, v2, 1, 1
    v_lshrrev_b32 v12, 1, v12
    v_and_b32 v15, 1, v5
    v_lshlrev_b32 v15, 1, v15
    v_or_b32 v12, v12, v15
    s_lshl_b32 s25, s23, 1
    v_xor_b32 v15, s25, v12
    v_lshl_or_b32 v15, v15, 1, v14
    v_lshl_add_u32 v16, v15, 4, v13
    s_add_u32 s25, s25, 1
    v_xor_b32 v15, s25, v12
    v_lshl_or_b32 v15, v15, 1, v14
    v_lshl_add_u32 v17, v15, 4, v13
    v_lshlrev_b32 v21, 8, v4
    v_lshl_add_u32 v21, v5, 4, v21
    s_lshl_b32 s25, s23, 7
    s_lshl_b32 s26, s58, 8
    s_add_u32 s25, s25, s26
    v_add_u32 v21, s25, v21
    v_cmp_gt_u32 vcc, s59, v4
    v_mov_b32 v22, 1073741824
    s_mov_b32 s27, 0xbfb8aa3b
    s_mov_b32 s28, 0xffff0000
    v_cndmask_b32 v9, v22, v21, vcc
    s_mov_b32 s29, 0x80000000
    v_mov_b32 v10, 0
    v_mov_b32 v11, 1
    s_waitcnt vmcnt(2)
    ds_write_b128 v18, v[48:51] offset:15360
    ds_write_b128 v19, v[52:55] offset:15360
    s_cmp_lt_u32 s21, 4
    s_cbranch_scc0 K1_T_ST2
    ds_write_b128 v20, v[56:59] offset:15360
K1_T_ST2:
    s_waitcnt lgkmcnt(0)
    s_mov_b64 exec, 1
    ds_add_u32 v10, v11 offset:2048
    s_mov_b64 exec, -1
K1_T_SPIN:
    ds_read_b32 v12, v10 offset:2048
    s_waitcnt lgkmcnt(0)
    v_readfirstlane_b32 s26, v12
    s_cmp_lt_u32 s26, 6
    s_cbranch_scc1 K1_T_SPIN
    ds_read_b64_tr_b16 v[64:65], v16 offset:15360
    ds_read_b64_tr_b16 v[66:67], v16 offset:15872
    ds_read_b64_tr_b16 v[68:69], v16 offset:23552
    ds_read_b64_tr_b16 v[70:71], v16 offset:24064
    ds_read_b64_tr_b16 v[72:73], v16 offset:19456
    ds_read_b64_tr_b16 v[74:75], v16 offset:19968
    ds_read_b64_tr_b16 v[76:77], v16 offset:27648
    ds_read_b64_tr_b16 v[78:79], v16 offset:28160
    ds_read_b64_tr_b16 v[80:81], v17 offset:15360
    ds_read_b64_tr_b16 v[82:83], v17 offset:15872
    ds_read_b64_tr_b16 v[84:85], v17 offset:23552
    ds_read_b64_tr_b16 v[86:87], v17 offset:24064
    ds_read_b64_tr_b16 v[88:89], v17 offset:19456
    ds_read_b64_tr_b16 v[90:91], v17 offset:19968
    ds_read_b64_tr_b16 v[92:93], v17 offset:27648
    ds_read_b64_tr_b16 v[94:95], v17 offset:28160
    s_waitcnt vmcnt(0)
    s_waitcnt lgkmcnt(14)
    v_mfma_f32_16x16x32_bf16 v[32:35], v[64:67], v[24:27], 0
    s_waitcnt lgkmcnt(12)
    v_mfma_f32_16x16x32_bf16 v[40:43], v[68:71], v[24:27], 0
    s_waitcnt lgkmcnt(10)
    v_mfma_f32_16x16x32_bf16 v[32:35], v[72:75], v[28:31], v[32:35]
    s_waitcnt lgkmcnt(8)
    v_mfma_f32_16x16x32_bf16 v[40:43], v[76:79], v[28:31], v[40:43]
    s_waitcnt lgkmcnt(6)
    v_mfma_f32_16x16x32_bf16 v[36:39], v[80:83], v[24:27], 0
    s_waitcnt lgkmcnt(4)
    v_mfma_f32_16x16x32_bf16 v[44:47], v[84:87], v[24:27], 0
    s_waitcnt lgkmcnt(2)
    v_mfma_f32_16x16x32_bf16 v[36:39], v[88:91], v[28:31], v[36:39]
    s_waitcnt lgkmcnt(0)
    v_mfma_f32_16x16x32_bf16 v[44:47], v[92:95], v[28:31], v[44:47]
    s_nop 4
    v_mul_f32 v32, s27, v32
    v_mul_f32 v33, s27, v33
    v_mul_f32 v34, s27, v34
    v_mul_f32 v35, s27, v35
    v_cvt_f16_f32 v32, v32
    v_cvt_f16_f32 v33, v33
    v_cvt_f16_f32 v34, v34
    v_cvt_f16_f32 v35, v35
    v_and_b32 v10, 0x7fffffff, v40
    v_and_b32 v11, 0x7fffffff, v41
    v_and_b32 v12, 0x7fffffff, v42
    v_and_b32 v13, 0x7fffffff, v43
    v_and_b32 v32, 0xffff, v32
    v_and_b32 v33, 0xffff, v33
    v_and_b32 v34, 0xffff, v34
    v_and_b32 v35, 0xffff, v35
    v_sub_u32 v10, v10, v32
    v_sub_u32 v11, v11, v33
    v_sub_u32 v12, v12, v34
    v_sub_u32 v13, v13, v35
    v_add_u32 v10, 0x8000, v10
    v_add_u32 v11, 0x8000, v11
    v_add_u32 v12, 0x8000, v12
    v_add_u32 v13, 0x8000, v13
    v_max_i32 v10, 0, v10
    v_max_i32 v11, 0, v11
    v_max_i32 v12, 0, v12
    v_max_i32 v13, 0, v13
    v_and_or_b32 v10, v10, s28, v32
    v_and_or_b32 v11, v11, s28, v33
    v_and_or_b32 v12, v12, s28, v34
    v_and_or_b32 v13, v13, s28, v35
    v_and_or_b32 v32, v40, s29, v10
    v_and_or_b32 v33, v41, s29, v11
    v_and_or_b32 v34, v42, s29, v12
    v_and_or_b32 v35, v43, s29, v13
    buffer_store_dwordx4 v[32:35], v9, s[44:47], 0 offen offset:0 nt
    s_nop 2
    v_mul_f32 v36, s27, v36
    v_mul_f32 v37, s27, v37
    v_mul_f32 v38, s27, v38
    v_mul_f32 v39, s27, v39
    v_cvt_f16_f32 v36, v36
    v_cvt_f16_f32 v37, v37
    v_cvt_f16_f32 v38, v38
    v_cvt_f16_f32 v39, v39
    v_and_b32 v10, 0x7fffffff, v44
    v_and_b32 v11, 0x7fffffff, v45
    v_and_b32 v12, 0x7fffffff, v46
    v_and_b32 v13, 0x7fffffff, v47
    v_and_b32 v36, 0xffff, v36
    v_and_b32 v37, 0xffff, v37
    v_and_b32 v38, 0xffff, v38
    v_and_b32 v39, 0xffff, v39
    v_sub_u32 v10, v10, v36
    v_sub_u32 v11, v11, v37
    v_sub_u32 v12, v12, v38
    v_sub_u32 v13, v13, v39
    v_add_u32 v10, 0x8000, v10
    v_add_u32 v11, 0x8000, v11
    v_add_u32 v12, 0x8000, v12
    v_add_u32 v13, 0x8000, v13
    v_max_i32 v10, 0, v10
    v_max_i32 v11, 0, v11
    v_max_i32 v12, 0, v12
    v_max_i32 v13, 0, v13
    v_and_or_b32 v10, v10, s28, v36
    v_and_or_b32 v11, v11, s28, v37
    v_and_or_b32 v12, v12, s28, v38
    v_and_or_b32 v13, v13, s28, v39
    v_and_or_b32 v36, v44, s29, v10
    v_and_or_b32 v37, v45, s29, v11
    v_and_or_b32 v38, v46, s29, v12
    v_and_or_b32 v39, v47, s29, v13
    buffer_store_dwordx4 v[36:39], v9, s[44:47], 0 offen offset:64 nt
    s_cmp_eq_u32 s2, 0
    s_cbranch_scc0 K1_TFIN
    s_cmp_eq_u32 s21, 0
    s_cbranch_scc0 K1_TFIN
    v_mov_b32 v10, 0x7c00
    v_lshlrev_b32 v11, 2, v2
    v_add_u32 v11, 2560000, v11
    buffer_store_dword v10, v11, s[44:47], 0 offen nt
K1_TFIN:
K1_END:
    s_endpgm
.globl k2_kernel
.p2align 8
.type k2_kernel,@function
k2_kernel:
    s_cmp_ge_u32 s2, 256
    s_cbranch_scc1 K2_END
    s_lshr_b32 s58, s2, 3
    s_and_b32 s47, s2, 7
    s_lshl_b32 s47, s47, 5
    s_add_u32 s2, s47, s58
    s_mul_i32 s62, s2, 625
    s_add_u32 s63, s62, 640
    s_add_u32 s62, s62, 15
    s_lshr_b32 s62, s62, 4
    s_lshr_b32 s63, s63, 4
    s_sub_u32 s63, s63, s62
    s_load_dwordx2 s[6:7], s[0:1], 88
    s_load_dwordx2 s[4:5], s[0:1], 0
    s_load_dwordx2 s[8:9], s[0:1], 32
    s_load_dwordx4 s[76:79], s[0:1], 48
    s_load_dwordx2 s[10:11], s[0:1], 72
    v_and_b32 v1, 63, v0
    v_lshrrev_b32 v108, 6, v0
    v_and_b32 v54, 15, v0
    v_readfirstlane_b32 s3, v108
    v_lshlrev_b32 v54, 4, v54
    v_and_b32 v108, 0x3fc, v0
    s_lshl_b32 s47, s2, 10
    v_mov_b32 v56, 0
    v_mov_b32 v60, 0
    v_mov_b32 v57, 0
    v_mov_b32 v61, 0
    v_mov_b32 v58, 0
    v_mov_b32 v62, 0
    v_mov_b32 v59, 0
    v_mov_b32 v63, 0
    v_cmp_gt_u32 vcc, 4, v0
    s_and_saveexec_b64 s[52:53], vcc
    v_lshlrev_b32 v113, 2, v0
    ds_write_b32 v113, v56 offset:256
    s_mov_b64 exec, s[52:53]
    s_mov_b32 s40, 0
    s_mov_b32 s41, 0
    v_mov_b32 v48, 0
    v_mov_b32 v49, 0
    v_mov_b32 v40, 10000
    v_mov_b32 v41, v54
    v_mov_b32 v42, 10000
    v_mov_b32 v43, v54
    v_mov_b32 v44, 10000
    v_mov_b32 v45, v54
    v_mov_b32 v46, 10000
    v_mov_b32 v47, v54
    v_lshrrev_b32 v109, 5, v1
    v_lshl_add_u32 v66, v109, 8, v54
    v_bfe_u32 v109, v1, 4, 1
    v_lshl_add_u32 v66, v109, 3, v66
K2_PASS:
    v_mov_b32 v114, 10000
    v_mov_b32 v115, 10000
    v_mov_b32 v116, 10000
    v_mov_b32 v117, 10000
    v_lshlrev_b32 v113, 4, v0
    ds_write_b128 v113, v[114:117] offset:512
    v_cmp_gt_u32 vcc, 64, v0
    s_and_saveexec_b64 s[52:53], vcc
    v_lshlrev_b32 v112, 2, v0
    v_mov_b32 v111, 0
    ds_write_b32 v112, v111 offset:0
    s_mov_b64 exec, s[52:53]
    s_cmp_eq_u32 s40, 0
    s_cbranch_scc0 K2_SLOWPARAM
    s_waitcnt lgkmcnt(0)
    s_add_u32 s12, s6, 3407872
    s_addc_u32 s13, s7, 0
    s_mov_b32 s14, 262144
    s_mov_b32 s15, 0x00020000
    buffer_load_dword v118, v108, s[12:15], s47 offen
    s_cmp_lt_u32 s3, 8
    s_cselect_b32 s24, s8, s78
    s_cselect_b32 s25, s9, s79
    s_mov_b32 s26, 8192
    s_mov_b32 s27, 0x00020000
    s_mov_b32 s28, s4
    s_mov_b32 s29, s5
    s_mov_b32 s30, 1280000
    s_mov_b32 s31, 0x00020000
    s_mov_b32 s36, s76
    s_mov_b32 s37, s77
    s_mov_b32 s38, 128
    s_mov_b32 s39, 0x00020000
    v_and_b32 v109, 511, v0
    v_lshlrev_b32 v109, 4, v109
    buffer_load_dwordx4 v[24:27], v109, s[24:27], 0 offen
    v_lshlrev_b32 v112, 4, v0
    v_cmp_gt_u32 vcc, 384, v0
    v_mov_b32 v111, 1073741824
    s_lshl_b32 s48, s62, 7
    v_cndmask_b32 v112, v111, v112, vcc
    buffer_load_dwordx4 v[68:71], v112, s[28:31], s48 offen
    v_lshrrev_b32 v115, 1, v54
    buffer_load_dwordx2 v[4:5], v115, s[36:39], 0 offen
    s_mov_b32 s32, s10
    s_mov_b32 s33, s11
    s_mov_b32 s34, 1280000
    s_mov_b32 s35, 0x00020000
    s_mov_b32 s16, s6
    s_mov_b32 s17, s7
    s_mov_b32 s18, 3200064
    s_mov_b32 s19, 0x00020000
    s_add_u32 s20, s6, 4194304
    s_addc_u32 s21, s7, 0
    s_and_b32 s21, s21, 0xffff
    s_or_b32 s21, s21, 16777216
    s_mov_b32 s22, 10001
    s_mov_b32 s23, 0x00020000
    v_lshrrev_b32 v108, 2, v0
    v_mul_u32_u24 v119, 12500, v108
    v_and_b32 v120, 3, v0
    v_lshlrev_b32 v120, 2, v120
    v_mad_u32_u24 v119, v120, 5, v119
    s_mov_b32 s48, 16
    s_waitcnt vmcnt(3)
    v_and_b32 v109, 0xffff, v118
    v_lshrrev_b32 v118, 16, v118
    v_mad_u32_u24 v119, v109, 5, v119
    s_branch K2_PARAMDONE
K2_SLOWPARAM:
    s_lshl_b32 s47, s2, 10
    s_lshl_b32 s48, s41, 2
    s_add_u32 s47, s47, s48
    v_mov_b32 v108, 0
    buffer_load_dword v118, v108, s[12:15], s47 offen
    s_mul_i32 s47, s41, 12500
    s_waitcnt vmcnt(0) lgkmcnt(0)
    s_barrier
    v_and_b32 v109, 0xffff, v118
    v_lshlrev_b32 v120, 2, v0
    v_add_u32 v109, v109, v120
    v_mul_u32_u24 v119, 5, v109
    v_add_u32 v119, s47, v119
    v_lshrrev_b32 v118, 16, v118
    s_mov_b32 s48, 4096
K2_PARAMDONE:
    v_sub_u32 v121, v118, v120
    s_mul_i32 s47, s48, 5
    s_mov_b32 s59, 0
    v_cmp_lt_i32 s[64:65], 0, v121
    v_cmp_gt_i32 s[66:67], v121, 1
    v_cmp_gt_i32 s[68:69], v121, 2
    v_cmp_gt_i32 s[70:71], v121, 3
    s_cmp_eq_u64 s[64:65], 0
    s_cbranch_scc1 K2_LD_DONE
    s_mov_b64 exec, s[64:65]
    buffer_load_dwordx4 v[76:79], v119, s[16:19], 0 offen
    buffer_load_dword v12, v119, s[16:19], 0 offen offset:16
    s_mov_b64 exec, -1
    s_mov_b32 s59, 1
    v_add_u32 v119, s47, v119
    v_subrev_u32 v121, s48, v121
    v_cmp_lt_i32 s[72:73], 0, v121
    v_cmp_gt_i32 s[74:75], v121, 1
    v_cmp_gt_i32 s[76:77], v121, 2
    v_cmp_gt_i32 s[78:79], v121, 3
    s_cmp_eq_u64 s[72:73], 0
    s_cbranch_scc1 K2_LD_DONE
    s_mov_b64 exec, s[72:73]
    buffer_load_dwordx4 v[80:83], v119, s[16:19], 0 offen
    buffer_load_dword v13, v119, s[16:19], 0 offen offset:16
    s_mov_b64 exec, -1
    s_mov_b32 s59, 2
K2_LD_DONE:
    s_or_b32 s47, s40, s41
    s_cmp_eq_u32 s47, 0
    s_cbranch_scc0 K2_LATER_PASS
    v_lshrrev_b32 v116, 3, v0
    v_mul_u32_u24 v116, 144, v116
    v_and_b32 v115, 7, v0
    v_lshl_add_u32 v116, v115, 4, v116
    v_add_u32 v116, 71680, v116
    v_bfe_u32 v109, v0, 4, 1
    v_bfe_u32 v110, v0, 6, 1
    v_lshlrev_b32 v109, 1, v109
    v_lshl_or_b32 v109, v110, 2, v109
    v_and_b32 v110, 7, v0
    v_xor_b32 v109, v109, v110
    v_lshrrev_b32 v110, 3, v0
    v_lshlrev_b32 v110, 7, v110
    v_lshl_add_u32 v117, v109, 4, v110
    v_add_u32 v117, 78592, v117
    v_lshrrev_b32 v111, 4, v1
    v_bfe_u32 v108, v1, 2, 2
    v_lshl_add_u32 v109, v111, 3, v108
    v_lshlrev_b32 v109, 7, v109
    v_and_b32 v110, 1, v1
    v_lshl_add_u32 v109, v110, 3, v109
    v_lshrrev_b32 v108, 1, v108
    v_and_b32 v110, 1, v111
    v_lshl_or_b32 v108, v110, 1, v108
    s_and_b32 s47, s3, 3
    v_xor_b32 v108, s47, v108
    v_bfe_u32 v110, v1, 1, 1
    v_lshl_or_b32 v108, v108, 1, v110
    v_lshl_add_u32 v122, v108, 4, v109
    v_add_u32 v122, 78592, v122
    s_lshr_b32 s48, s3, 2
    s_lshl_b32 s48, s48, 4
    v_and_b32 v110, 15, v1
    v_add_u32 v121, s48, v110
    v_mul_u32_u24 v109, 144, v121
    v_lshl_add_u32 v109, v111, 4, v109
    v_add_u32 v123, 71680, v109
    v_mul_u32_u24 v112, 272, v121
    v_lshl_add_u32 v112, v111, 4, v112
    s_lshl_b32 s47, s47, 6
    s_add_u32 s47, s47, 45568
    v_add_u32 v52, s47, v112
    s_add_u32 s24, s6, 4194304
    s_addc_u32 s25, s7, 0
    s_mov_b32 s26, 2560256
    s_mov_b32 s27, 0x00020000
    s_mul_i32 s47, s58, 81920
    s_mul_i32 s48, s3, 5120
    s_add_u32 s58, s47, s48
    v_lshlrev_b32 v111, 7, v1
    v_cmp_gt_u32 vcc, 20, v1
    v_mov_b32 v112, 1073741824
    s_nop 0
    v_cndmask_b32 v51, v112, v111, vcc
    s_cmp_eq_u32 s59, 2
    s_cbranch_scc1 K2_WW4
    s_cmp_eq_u32 s59, 1
    s_cbranch_scc1 K2_WW2
    s_waitcnt vmcnt(0)
    s_branch K2_WWD
K2_WW4:
    s_waitcnt vmcnt(4)
    s_branch K2_WWD
K2_WW2:
    s_waitcnt vmcnt(2)
K2_WWD:
    ds_write_b128 v117, v[24:27]
    s_cmp_lt_u32 s3, 6
    s_cbranch_scc0 K2_NOXST0
    ds_write_b128 v116, v[68:71]
K2_NOXST0:
    s_waitcnt lgkmcnt(0)
    s_barrier
    s_cmp_lt_u32 s3, 12
    s_cbranch_scc0 K2_NOMFMA0
    ds_read_b128 v[68:71], v123
    ds_read_b64_tr_b16 v[24:25], v122
    ds_read_b64_tr_b16 v[26:27], v122 offset:512
    ds_read_b128 v[72:75], v123 offset:64
    ds_read_b64_tr_b16 v[28:29], v122 offset:4096
    ds_read_b64_tr_b16 v[30:31], v122 offset:4608
    s_mov_b32 s47, 0xbfb8aa3b
    s_mov_b32 s48, 0x42700000
    s_waitcnt lgkmcnt(3)
    v_mfma_f32_16x16x32_bf16 v[20:23], v[24:27], v[68:71], 0
    s_waitcnt lgkmcnt(0)
    v_mfma_f32_16x16x32_bf16 v[20:23], v[28:31], v[72:75], v[20:23]
    s_nop 7
    v_mul_f32 v20, s47, v20
    v_mul_f32 v21, s47, v21
    v_mul_f32 v22, s47, v22
    v_mul_f32 v23, s47, v23
    v_exp_f32 v24, v20
    v_exp_f32 v25, v21
    v_exp_f32 v26, v22
    v_exp_f32 v27, v23
    v_max3_f32 v113, |v20|, |v21|, |v22|
    v_max_f32 v113, v113, |v23|
    ds_write_b128 v52, v[24:27]
    v_cmp_nle_f32 vcc, v113, s48
    v_cmp_gt_u32 s[52:53], s63, v121
    s_and_b64 vcc, vcc, s[52:53]
    s_and_saveexec_b64 s[52:53], vcc
    s_cbranch_execz K2_GUARD_OK0
    v_mov_b32 v113, 1
    v_mov_b32 v115, 0
    ds_write_b32 v115, v113 offset:260
K2_GUARD_OK0:
    s_mov_b64 exec, s[52:53]
K2_NOMFMA0:
K2_LATER_PASS:
    v_mov_b32 v110, 1
    s_waitcnt vmcnt(0)
    s_or_b32 s47, s40, s41
    s_cmp_eq_u32 s47, 0
    s_cbranch_scc0 K2_RANKS
    buffer_load_dword v16, v51, s[24:27], s58 offen
K2_RANKS:
    s_cmp_le_u32 s59, 0
    s_cbranch_scc1 K2_RK_DONE
    v_and_b32 v100, 0xff, v77
    v_bfe_u32 v101, v78, 8, 8
    v_bfe_u32 v102, v79, 16, 8
    v_lshrrev_b32 v103, 24, v12
    s_mov_b64 exec, s[64:65]
    ds_add_rtn_u32 v92, v100, v110 offset:0
    s_mov_b64 exec, s[66:67]
    ds_add_rtn_u32 v93, v101, v110 offset:0
    s_mov_b64 exec, s[68:69]
    ds_add_rtn_u32 v94, v102, v110 offset:0
    s_mov_b64 exec, s[70:71]
    ds_add_rtn_u32 v95, v103, v110 offset:0
    s_mov_b64 exec, -1
    v_alignbyte_b32 v77, v78, v77, 1
    v_alignbyte_b32 v78, v79, v78, 2
    v_alignbyte_b32 v79, v12, v79, 3
    s_cmp_le_u32 s59, 1
    s_cbranch_scc1 K2_RK_DONE
    v_and_b32 v104, 0xff, v81
    v_bfe_u32 v105, v82, 8, 8
    v_bfe_u32 v106, v83, 16, 8
    v_lshrrev_b32 v107, 24, v13
    s_mov_b64 exec, s[72:73]
    ds_add_rtn_u32 v96, v104, v110 offset:0
    s_mov_b64 exec, s[74:75]
    ds_add_rtn_u32 v97, v105, v110 offset:0
    s_mov_b64 exec, s[76:77]
    ds_add_rtn_u32 v98, v106, v110 offset:0
    s_mov_b64 exec, s[78:79]
    ds_add_rtn_u32 v99, v107, v110 offset:0
    s_mov_b64 exec, -1
    v_alignbyte_b32 v81, v82, v81, 1
    v_alignbyte_b32 v82, v83, v82, 2
    v_alignbyte_b32 v83, v13, v83, 3
K2_RK_DONE:
    v_cmp_lt_u32 vcc, 32, v118
    s_and_saveexec_b64 s[52:53], vcc
    s_cbranch_execz K2_NOOVF
    v_mov_b32 v111, 0
    ds_write_b32 v111, v110 offset:256
K2_NOOVF:
    s_mov_b64 exec, s[52:53]
    s_or_b32 s47, s40, s41
    s_cmp_eq_u32 s47, 0
    s_cbranch_scc0 K2_NOWST
    s_mov_b32 s47, 0xbfb8aa3b
    v_and_b32 v7, 0xffff0000, v5
    v_lshlrev_b32 v6, 16, v5
    v_and_b32 v5, 0xffff0000, v4
    v_lshlrev_b32 v4, 16, v4
    v_mul_f32 v4, s47, v4
    v_mul_f32 v5, s47, v5
    v_mul_f32 v6, s47, v6
    v_mul_f32 v7, s47, v7
K2_NOWST:
    v_lshlrev_b32 v109, 2, v1
    v_mov_b32 v108, 0
    s_waitcnt lgkmcnt(0)
    s_barrier
    ds_read_b32 v55, v109 offset:0
    ds_read_b32 v112, v108 offset:256
    s_waitcnt lgkmcnt(1)
    v_add_u32 v55, 3, v55
    v_lshrrev_b32 v55, 2, v55
    v_mov_b32 v67, v55
    s_nop 1
    v_add_u32_dpp v67, v67, v67 row_shr:1 row_mask:0xf bank_mask:0xf
    s_nop 1
    v_add_u32_dpp v67, v67, v67 row_shr:2 row_mask:0xf bank_mask:0xf
    s_nop 1
    v_add_u32_dpp v67, v67, v67 row_shr:4 row_mask:0xf bank_mask:0xf
    s_nop 1
    v_add_u32_dpp v67, v67, v67 row_shr:8 row_mask:0xf bank_mask:0xf
    s_nop 1
    v_add_u32_dpp v67, v67, v67 row_bcast:15 row_mask:0xa bank_mask:0xf
    s_nop 1
    v_add_u32_dpp v67, v67, v67 row_bcast:31 row_mask:0xc bank_mask:0xf
    s_waitcnt lgkmcnt(0)
    v_readlane_b32 s50, v67, 39
    v_sub_u32 v53, v67, v55
    v_readfirstlane_b32 s47, v112
    v_lshlrev_b32 v114, 4, v53
    v_cmp_lt_u32 vcc, 40, v1
    s_add_u32 s51, s50, 15
    s_lshr_b32 s51, s51, 4
    v_cndmask_b32 v53, v53, -1, vcc
    s_cmp_eq_u32 s40, 0
    s_cbranch_scc0 K2_NOSWITCH
    s_cmp_gt_u32 s50, 1008
    s_cselect_b32 s48, 1, 0
    s_or_b32 s47, s47, s48
    s_cmp_eq_u32 s47, 0
    s_cbranch_scc1 K2_NOSWITCH
    s_mov_b32 s59, 0
    s_mov_b32 s50, 0
    s_mov_b32 s51, 0
    s_mov_b32 s40, 2
K2_NOSWITCH:
    s_cmp_le_u32 s59, 0
    s_cbranch_scc1 K2_LK_DONE
    ds_bpermute_b32 v84, v100, v114
    ds_bpermute_b32 v85, v101, v114
    ds_bpermute_b32 v86, v102, v114
    ds_bpermute_b32 v87, v103, v114
    s_cmp_le_u32 s59, 1
    s_cbranch_scc1 K2_LK_DONE
    ds_bpermute_b32 v88, v104, v114
    ds_bpermute_b32 v89, v105, v114
    ds_bpermute_b32 v90, v106, v114
    ds_bpermute_b32 v91, v107, v114
K2_LK_DONE:
    s_waitcnt lgkmcnt(0)
    s_cmp_le_u32 s59, 0
    s_cbranch_scc1 K2_SC_DONE
    s_mov_b64 exec, s[64:65]
    v_lshl_add_u32 v84, v92, 2, v84
    ds_write_b32 v84, v76 offset:512
    s_mov_b64 exec, s[66:67]
    v_lshl_add_u32 v85, v93, 2, v85
    ds_write_b32 v85, v77 offset:512
    s_mov_b64 exec, s[68:69]
    v_lshl_add_u32 v86, v94, 2, v86
    ds_write_b32 v86, v78 offset:512
    s_mov_b64 exec, s[70:71]
    v_lshl_add_u32 v87, v95, 2, v87
    ds_write_b32 v87, v79 offset:512
    s_cmp_le_u32 s59, 1
    s_cbranch_scc1 K2_SC_DONE
    s_mov_b64 exec, s[72:73]
    v_lshl_add_u32 v88, v96, 2, v88
    ds_write_b32 v88, v80 offset:512
    s_mov_b64 exec, s[74:75]
    v_lshl_add_u32 v89, v97, 2, v89
    ds_write_b32 v89, v81 offset:512
    s_mov_b64 exec, s[76:77]
    v_lshl_add_u32 v90, v98, 2, v90
    ds_write_b32 v90, v82 offset:512
    s_mov_b64 exec, s[78:79]
    v_lshl_add_u32 v91, v99, 2, v91
    ds_write_b32 v91, v83 offset:512
K2_SC_DONE:
    s_mov_b64 exec, -1
    s_mul_i32 s42, s51, s3
    s_add_u32 s43, s42, s51
    s_min_u32 s43, s43, s50
    v_lshrrev_b32 v50, 4, v1
    v_lshlrev_b32 v50, 2, v50
    s_lshl_b32 s47, s42, 4
    v_add_u32 v50, s47, v50
    v_mov_b32 v108, 0
    s_waitcnt lgkmcnt(0)
    s_barrier
    s_setprio 3
    s_cmp_ge_u32 s42, s43
    s_cbranch_scc1 K2_NOGATH
    ds_read_u16 v40, v50 offset:512
    ds_read_u16 v42, v50 offset:528
    ds_read_u16 v44, v50 offset:544
    ds_read_u16 v46, v50 offset:560
    ds_read_u16_d16_hi v48, v50 offset:514
    s_waitcnt lgkmcnt(0)
    buffer_load_dwordx4 v[24:27], v[40:41], s[20:23], 0 idxen offen
    ds_read_u16 v40, v50 offset:576
K2_NOGATH:
    s_cmp_eq_u32 s41, 0
    s_cbranch_scc0 K2_NOTAB
    s_cmp_eq_u32 s40, 1
    s_cbranch_scc1 K2_NOTAB
K2_NOMFMA:
    v_mov_b32 v108, 0
    ds_read_b32 v113, v108 offset:260
    s_cmp_ge_u32 s42, s43
    s_cbranch_scc1 K2_NOGATH2
    buffer_load_dwordx4 v[28:31], v[42:43], s[20:23], 0 idxen offen
    buffer_load_dwordx4 v[32:35], v[44:45], s[20:23], 0 idxen offen
    buffer_load_dwordx4 v[36:39], v[46:47], s[20:23], 0 idxen offen
K2_NOGATH2:
    s_cmp_lt_u32 s3, 12
    s_cbranch_scc0 K2_NOU
    ds_read_b64_tr_b16 v[76:77], v122 offset:8192
    ds_read_b64_tr_b16 v[78:79], v122 offset:8704
    ds_read_b64_tr_b16 v[80:81], v122 offset:12288
    ds_read_b64_tr_b16 v[82:83], v122 offset:12800
    s_waitcnt lgkmcnt(2)
    v_mfma_f32_16x16x32_bf16 v[96:99], v[76:79], v[68:71], 0
    s_waitcnt lgkmcnt(0)
    v_mfma_f32_16x16x32_bf16 v[96:99], v[80:83], v[72:75], v[96:99]
    v_mov_b32 v100, v52
K2_NOU:
    s_waitcnt lgkmcnt(0)
    v_readfirstlane_b32 s49, v113
    s_nop 0
    s_cmp_eq_u32 s49, 0
    s_cbranch_scc1 K2_WAITW
    s_barrier
    s_cmp_lt_u32 s3, 12
    s_cbranch_scc0 K2_SAFE_NOW
    ds_write_b128 v52, v[20:23]
K2_SAFE_NOW:
    s_waitcnt lgkmcnt(0)
    s_barrier
K2_WAITW:
    s_branch K2_TABDONE
K2_NOTAB:
    s_cmp_ge_u32 s42, s43
    s_cbranch_scc1 K2_TABDONE
    buffer_load_dwordx4 v[28:31], v[42:43], s[20:23], 0 idxen offen
    buffer_load_dwordx4 v[32:35], v[44:45], s[20:23], 0 idxen offen
    buffer_load_dwordx4 v[36:39], v[46:47], s[20:23], 0 idxen offen
K2_TABDONE:
    s_mov_b64 s[64:65], 0
    s_mov_b64 s[66:67], 0
    s_mov_b64 s[68:69], 0
    s_lshl_b32 s61, s63, 4
    s_cmp_lt_u32 s3, 10
    s_cbranch_scc0 K2_NOSPAN
    v_cvt_f32_u32 v108, s51
    v_cvt_f32_u32 v109, v53
    v_rcp_f32 v108, v108
    v_cvt_f32_u32 v110, v67
    v_add_f32 v109, 0.5, v109
    v_add_f32 v110, -0.5, v110
    v_mul_f32 v109, v109, v108
    v_mul_f32 v110, v110, v108
    v_cvt_u32_f32 v109, v109
    v_cvt_u32_f32 v110, v110
    v_sub_u32 v110, v110, v109
    v_add_u32 v110, 1, v110
    v_cmp_eq_u32 vcc, 0, v55
    v_add_u32 v109, v109, v1
    v_and_b32 v109, 0xffff, v109
    v_cndmask_b32 v110, v110, 0, vcc
    v_lshl_or_b32 v111, v110, 16, v109
    v_lshrrev_b32 v108, 4, v0
    v_and_b32 v112, 63, v108
    v_lshlrev_b32 v112, 2, v112
    ds_bpermute_b32 v109, v112, v111
    v_mul_u32_u24 v103, 272, v108
    v_mul_u32_u24 v106, 144, v108
    v_lshrrev_b32 v115, 1, v54
    v_add_u32 v103, v103, v54
    v_add_u32 v106, v106, v115
    v_add_u32 v103, 58624, v103
    v_add_u32 v106, 71680, v106
    s_lshl_b32 s61, s63, 4
    v_cmp_gt_u32 vcc, s61, v0
    s_waitcnt lgkmcnt(0)
    v_lshrrev_b32 v102, 16, v109
    v_and_b32 v109, 0xffff, v109
    v_cndmask_b32 v102, 0, v102, vcc
    v_lshl_add_u32 v101, v109, 9, v54
    v_cmp_lt_u32 s[64:65], 0, v102
    v_cmp_lt_u32 s[66:67], 1, v102
    v_cmp_lt_u32 s[68:69], 2, v102
K2_NOSPAN:
    s_cmp_ge_u32 s42, s43
    s_cbranch_scc1 K2_MAIN_DONE
    s_add_u32 s47, s51, 3
    s_lshr_b32 s47, s47, 2
    s_mul_i32 s55, s47, 9
    s_lshr_b32 s55, s55, 4
    s_add_u32 s55, s55, 1
    s_mul_i32 s56, s47, 4
    s_lshr_b32 s56, s56, 4
    s_add_u32 s56, s56, 1
    s_mul_i32 s60, s47, 2
    s_lshr_b32 s60, s60, 4
    s_add_u32 s60, s60, 1
    s_mov_b32 s57, 3
    s_setprio 3
    s_mov_b32 s44, s42
    s_mov_b32 s54, 45568
    s_cmp_eq_u32 s49, 0
    s_cbranch_scc0 K2S_ENTER
    s_branch K2F_ENTER
K2F_ENTER:
    v_cmp_ge_u32 vcc, s44, v53
    s_bcnt1_i32_b64 s47, vcc
    s_sub_u32 s46, s47, 1
    v_readlane_b32 s48, v53, s47
    s_mul_i32 s47, s46, 272
    s_add_u32 s47, s47, s54
    v_add_u32 v52, s47, v54
    ds_read_b128 v[8:11], v52
    s_min_u32 s48, s48, s43
    s_sub_u32 s45, s48, s44
    s_sub_u32 s45, s45, 1
    s_mov_b32 s44, s48
    s_add_u32 s58, s46, s3
    s_lshl_b32 s58, s58, 9
    s_waitcnt vmcnt(3) lgkmcnt(0)
    v_fma_mix_f32 v20, v48, v4, v24 op_sel:[0,0,0] op_sel_hi:[0,0,1]
    v_fma_mix_f32 v21, v48, v5, v25 op_sel:[0,0,0] op_sel_hi:[0,0,1]
    v_fma_mix_f32 v22, v48, v6, v26 op_sel:[0,0,0] op_sel_hi:[0,0,1]
    v_fma_mix_f32 v23, v48, v7, v27 op_sel:[0,0,0] op_sel_hi:[0,0,1]
    ds_read_u16_d16_hi v49, v50 offset:530
    ds_read_u16 v42, v50 offset:592
    v_exp_f32 v20, v20
    v_exp_f32 v21, v21
    v_exp_f32 v22, v22
    v_exp_f32 v23, v23
    s_waitcnt lgkmcnt(3)
    v_pk_fma_f32 v[20:21], v[8:9], v[20:21], 1.0 op_sel_hi:[1,1,0]
    v_pk_fma_f32 v[22:23], v[10:11], v[22:23], 1.0 op_sel_hi:[1,1,0]
    v_rcp_f32 v12, v20
    v_rcp_f32 v13, v21
    v_rcp_f32 v14, v22
    v_rcp_f32 v15, v23
    s_nop 0
    v_pk_mul_f32 v[16:17], v[12:13], v[24:25]
    v_pk_mul_f32 v[18:19], v[14:15], v[26:27]
    buffer_load_dwordx4 v[24:27], v[40:41], s[20:23], 0 idxen offen
    s_branch K2F_STEP1
K2F_STEP0:
    s_waitcnt vmcnt(3) lgkmcnt(0)
    s_sub_u32 s45, s45, 1
    s_cbranch_scc1 K2F_FLUSH0
    v_fma_mix_f32 v20, v48, v4, v24 op_sel:[0,0,0] op_sel_hi:[0,0,1]
    v_fma_mix_f32 v21, v48, v5, v25 op_sel:[0,0,0] op_sel_hi:[0,0,1]
    v_fma_mix_f32 v22, v48, v6, v26 op_sel:[0,0,0] op_sel_hi:[0,0,1]
    v_fma_mix_f32 v23, v48, v7, v27 op_sel:[0,0,0] op_sel_hi:[0,0,1]
    ds_read_u16_d16_hi v49, v50 offset:530
    ds_read_u16 v42, v50 offset:592
    v_exp_f32 v20, v20
    v_exp_f32 v21, v21
    v_exp_f32 v22, v22
    v_exp_f32 v23, v23
    v_pk_fma_f32 v[20:21], v[8:9], v[20:21], 1.0 op_sel_hi:[1,1,0]
    v_pk_fma_f32 v[22:23], v[10:11], v[22:23], 1.0 op_sel_hi:[1,1,0]
    v_rcp_f32 v20, v20
    v_rcp_f32 v21, v21
    v_rcp_f32 v22, v22
    v_rcp_f32 v23, v23
    v_pk_add_f32 v[12:13], v[12:13], v[20:21]
    v_pk_add_f32 v[14:15], v[14:15], v[22:23]
    v_pk_fma_f32 v[16:17], v[20:21], v[24:25], v[16:17]
    v_pk_fma_f32 v[18:19], v[22:23], v[26:27], v[18:19]
    buffer_load_dwordx4 v[24:27], v[40:41], s[20:23], 0 idxen offen
K2F_STEP1:
    s_waitcnt vmcnt(3) lgkmcnt(0)
    s_sub_u32 s45, s45, 1
    s_cbranch_scc1 K2F_FLUSH1
    v_fma_mix_f32 v20, v49, v4, v28 op_sel:[0,0,0] op_sel_hi:[0,0,1]
    v_fma_mix_f32 v21, v49, v5, v29 op_sel:[0,0,0] op_sel_hi:[0,0,1]
    v_fma_mix_f32 v22, v49, v6, v30 op_sel:[0,0,0] op_sel_hi:[0,0,1]
    v_fma_mix_f32 v23, v49, v7, v31 op_sel:[0,0,0] op_sel_hi:[0,0,1]
    ds_read_u16_d16_hi v48, v50 offset:546
    ds_read_u16 v44, v50 offset:608
    v_exp_f32 v20, v20
    v_exp_f32 v21, v21
    v_exp_f32 v22, v22
    v_exp_f32 v23, v23
    v_pk_fma_f32 v[20:21], v[8:9], v[20:21], 1.0 op_sel_hi:[1,1,0]
    v_pk_fma_f32 v[22:23], v[10:11], v[22:23], 1.0 op_sel_hi:[1,1,0]
    v_rcp_f32 v20, v20
    v_rcp_f32 v21, v21
    v_rcp_f32 v22, v22
    v_rcp_f32 v23, v23
    v_pk_add_f32 v[12:13], v[12:13], v[20:21]
    v_pk_add_f32 v[14:15], v[14:15], v[22:23]
    v_pk_fma_f32 v[16:17], v[20:21], v[28:29], v[16:17]
    v_pk_fma_f32 v[18:19], v[22:23], v[30:31], v[18:19]
    buffer_load_dwordx4 v[28:31], v[42:43], s[20:23], 0 idxen offen
K2F_STEP2:
    s_waitcnt vmcnt(3) lgkmcnt(0)
    s_sub_u32 s45, s45, 1
    s_cbranch_scc1 K2F_FLUSH2
    v_fma_mix_f32 v20, v48, v4, v32 op_sel:[0,0,0] op_sel_hi:[0,0,1]
    v_fma_mix_f32 v21, v48, v5, v33 op_sel:[0,0,0] op_sel_hi:[0,0,1]
    v_fma_mix_f32 v22, v48, v6, v34 op_sel:[0,0,0] op_sel_hi:[0,0,1]
    v_fma_mix_f32 v23, v48, v7, v35 op_sel:[0,0,0] op_sel_hi:[0,0,1]
    ds_read_u16_d16_hi v49, v50 offset:562
    ds_read_u16 v46, v50 offset:624
    v_exp_f32 v20, v20
    v_exp_f32 v21, v21
    v_exp_f32 v22, v22
    v_exp_f32 v23, v23
    v_pk_fma_f32 v[20:21], v[8:9], v[20:21], 1.0 op_sel_hi:[1,1,0]
    v_pk_fma_f32 v[22:23], v[10:11], v[22:23], 1.0 op_sel_hi:[1,1,0]
    v_rcp_f32 v20, v20
    v_rcp_f32 v21, v21
    v_rcp_f32 v22, v22
    v_rcp_f32 v23, v23
    v_pk_add_f32 v[12:13], v[12:13], v[20:21]
    v_pk_add_f32 v[14:15], v[14:15], v[22:23]
    v_pk_fma_f32 v[16:17], v[20:21], v[32:33], v[16:17]
    v_pk_fma_f32 v[18:19], v[22:23], v[34:35], v[18:19]
    buffer_load_dwordx4 v[32:35], v[44:45], s[20:23], 0 idxen offen
K2F_STEP3:
    s_waitcnt vmcnt(3) lgkmcnt(0)
    s_sub_u32 s45, s45, 1
    s_cbranch_scc1 K2F_FLUSH3
    v_fma_mix_f32 v20, v49, v4, v36 op_sel:[0,0,0] op_sel_hi:[0,0,1]
    v_fma_mix_f32 v21, v49, v5, v37 op_sel:[0,0,0] op_sel_hi:[0,0,1]
    v_fma_mix_f32 v22, v49, v6, v38 op_sel:[0,0,0] op_sel_hi:[0,0,1]
    v_fma_mix_f32 v23, v49, v7, v39 op_sel:[0,0,0] op_sel_hi:[0,0,1]
    ds_read_u16_d16_hi v48, v50 offset:578
    ds_read_u16 v40, v50 offset:640
    v_exp_f32 v20, v20
    v_exp_f32 v21, v21
    v_exp_f32 v22, v22
    v_exp_f32 v23, v23
    v_pk_fma_f32 v[20:21], v[8:9], v[20:21], 1.0 op_sel_hi:[1,1,0]
    v_pk_fma_f32 v[22:23], v[10:11], v[22:23], 1.0 op_sel_hi:[1,1,0]
    v_rcp_f32 v20, v20
    v_rcp_f32 v21, v21
    v_rcp_f32 v22, v22
    v_rcp_f32 v23, v23
    v_pk_add_f32 v[12:13], v[12:13], v[20:21]
    v_pk_add_f32 v[14:15], v[14:15], v[22:23]
    v_pk_fma_f32 v[16:17], v[20:21], v[36:37], v[16:17]
    v_pk_fma_f32 v[18:19], v[22:23], v[38:39], v[18:19]
    buffer_load_dwordx4 v[36:39], v[46:47], s[20:23], 0 idxen offen
    v_add_u32 v50, 64, v50
    s_sub_u32 s55, s55, 1
    s_cmp_lg_u32 s55, 0
    s_cbranch_scc1 K2F_STEP0
    s_branch K2F_PRIO
K2F_FLUSH0:
    s_cmp_ge_u32 s44, s43
    s_cbranch_scc1 K2_LAST
    v_cmp_ge_u32 vcc, s44, v53
    s_bcnt1_i32_b64 s47, vcc
    s_sub_u32 s46, s47, 1
    v_readlane_b32 s48, v53, s47
    s_mul_i32 s47, s46, 272
    s_add_u32 s47, s47, s54
    v_add_u32 v52, s47, v54
    ds_read_b128 v[8:11], v52
    s_min_u32 s48, s48, s43
    s_sub_u32 s45, s48, s44
    s_sub_u32 s45, s45, 1
    s_mov_b32 s44, s48
    v_add_u32 v51, s58, v66
    v_permlane32_swap_b32 v12, v16
    v_permlane32_swap_b32 v13, v17
    v_permlane32_swap_b32 v14, v18
    v_permlane32_swap_b32 v15, v19
    v_pk_add_f32 v[12:13], v[12:13], v[16:17]
    v_pk_add_f32 v[14:15], v[14:15], v[18:19]
    s_nop 1
    v_permlane16_swap_b32 v12, v14
    v_permlane16_swap_b32 v13, v15
    v_pk_add_f32 v[16:17], v[12:13], v[14:15]
    ds_write_b64 v51, v[16:17] offset:16896
    s_add_u32 s58, s46, s3
    s_lshl_b32 s58, s58, 9
    v_fma_mix_f32 v20, v48, v4, v24 op_sel:[0,0,0] op_sel_hi:[0,0,1]
    v_fma_mix_f32 v21, v48, v5, v25 op_sel:[0,0,0] op_sel_hi:[0,0,1]
    v_fma_mix_f32 v22, v48, v6, v26 op_sel:[0,0,0] op_sel_hi:[0,0,1]
    v_fma_mix_f32 v23, v48, v7, v27 op_sel:[0,0,0] op_sel_hi:[0,0,1]
    ds_read_u16_d16_hi v49, v50 offset:530
    ds_read_u16 v42, v50 offset:592
    v_exp_f32 v20, v20
    v_exp_f32 v21, v21
    v_exp_f32 v22, v22
    v_exp_f32 v23, v23
    s_waitcnt lgkmcnt(3)
    v_pk_fma_f32 v[20:21], v[8:9], v[20:21], 1.0 op_sel_hi:[1,1,0]
    v_pk_fma_f32 v[22:23], v[10:11], v[22:23], 1.0 op_sel_hi:[1,1,0]
    v_rcp_f32 v12, v20
    v_rcp_f32 v13, v21
    v_rcp_f32 v14, v22
    v_rcp_f32 v15, v23
    s_nop 0
    v_pk_mul_f32 v[16:17], v[12:13], v[24:25]
    v_pk_mul_f32 v[18:19], v[14:15], v[26:27]
    buffer_load_dwordx4 v[24:27], v[40:41], s[20:23], 0 idxen offen
    s_branch K2F_STEP1
K2F_FLUSH1:
    s_cmp_ge_u32 s44, s43
    s_cbranch_scc1 K2_LAST
    v_cmp_ge_u32 vcc, s44, v53
    s_bcnt1_i32_b64 s47, vcc
    s_sub_u32 s46, s47, 1
    v_readlane_b32 s48, v53, s47
    s_mul_i32 s47, s46, 272
    s_add_u32 s47, s47, s54
    v_add_u32 v52, s47, v54
    ds_read_b128 v[8:11], v52
    s_min_u32 s48, s48, s43
    s_sub_u32 s45, s48, s44
    s_sub_u32 s45, s45, 1
    s_mov_b32 s44, s48
    v_add_u32 v51, s58, v66
    v_permlane32_swap_b32 v12, v16
    v_permlane32_swap_b32 v13, v17
    v_permlane32_swap_b32 v14, v18
    v_permlane32_swap_b32 v15, v19
    v_pk_add_f32 v[12:13], v[12:13], v[16:17]
    v_pk_add_f32 v[14:15], v[14:15], v[18:19]
    s_nop 1
    v_permlane16_swap_b32 v12, v14
    v_permlane16_swap_b32 v13, v15
    v_pk_add_f32 v[16:17], v[12:13], v[14:15]
    ds_write_b64 v51, v[16:17] offset:16896
    s_add_u32 s58, s46, s3
    s_lshl_b32 s58, s58, 9
    v_fma_mix_f32 v20, v49, v4, v28 op_sel:[0,0,0] op_sel_hi:[0,0,1]
    v_fma_mix_f32 v21, v49, v5, v29 op_sel:[0,0,0] op_sel_hi:[0,0,1]
    v_fma_mix_f32 v22, v49, v6, v30 op_sel:[0,0,0] op_sel_hi:[0,0,1]
    v_fma_mix_f32 v23, v49, v7, v31 op_sel:[0,0,0] op_sel_hi:[0,0,1]
    ds_read_u16_d16_hi v48, v50 offset:546
    ds_read_u16 v44, v50 offset:608
    v_exp_f32 v20, v20
    v_exp_f32 v21, v21
    v_exp_f32 v22, v22
    v_exp_f32 v23, v23
    s_waitcnt lgkmcnt(3)
    v_pk_fma_f32 v[20:21], v[8:9], v[20:21], 1.0 op_sel_hi:[1,1,0]
    v_pk_fma_f32 v[22:23], v[10:11], v[22:23], 1.0 op_sel_hi:[1,1,0]
    v_rcp_f32 v12, v20
    v_rcp_f32 v13, v21
    v_rcp_f32 v14, v22
    v_rcp_f32 v15, v23
    s_nop 0
    v_pk_mul_f32 v[16:17], v[12:13], v[28:29]
    v_pk_mul_f32 v[18:19], v[14:15], v[30:31]
    buffer_load_dwordx4 v[28:31], v[42:43], s[20:23], 0 idxen offen
    s_branch K2F_STEP2
K2F_FLUSH2:
    s_cmp_ge_u32 s44, s43
    s_cbranch_scc1 K2_LAST
    v_cmp_ge_u32 vcc, s44, v53
    s_bcnt1_i32_b64 s47, vcc
    s_sub_u32 s46, s47, 1
    v_readlane_b32 s48, v53, s47
    s_mul_i32 s47, s46, 272
    s_add_u32 s47, s47, s54
    v_add_u32 v52, s47, v54
    ds_read_b128 v[8:11], v52
    s_min_u32 s48, s48, s43
    s_sub_u32 s45, s48, s44
    s_sub_u32 s45, s45, 1
    s_mov_b32 s44, s48
    v_add_u32 v51, s58, v66
    v_permlane32_swap_b32 v12, v16
    v_permlane32_swap_b32 v13, v17
    v_permlane32_swap_b32 v14, v18
    v_permlane32_swap_b32 v15, v19
    v_pk_add_f32 v[12:13], v[12:13], v[16:17]
    v_pk_add_f32 v[14:15], v[14:15], v[18:19]
    s_nop 1
    v_permlane16_swap_b32 v12, v14
    v_permlane16_swap_b32 v13, v15
    v_pk_add_f32 v[16:17], v[12:13], v[14:15]
    ds_write_b64 v51, v[16:17] offset:16896
    s_add_u32 s58, s46, s3
    s_lshl_b32 s58, s58, 9
    v_fma_mix_f32 v20, v48, v4, v32 op_sel:[0,0,0] op_sel_hi:[0,0,1]
    v_fma_mix_f32 v21, v48, v5, v33 op_sel:[0,0,0] op_sel_hi:[0,0,1]
    v_fma_mix_f32 v22, v48, v6, v34 op_sel:[0,0,0] op_sel_hi:[0,0,1]
    v_fma_mix_f32 v23, v48, v7, v35 op_sel:[0,0,0] op_sel_hi:[0,0,1]
    ds_read_u16_d16_hi v49, v50 offset:562
    ds_read_u16 v46, v50 offset:624
    v_exp_f32 v20, v20
    v_exp_f32 v21, v21
    v_exp_f32 v22, v22
    v_exp_f32 v23, v23
    s_waitcnt lgkmcnt(3)
    v_pk_fma_f32 v[20:21], v[8:9], v[20:21], 1.0 op_sel_hi:[1,1,0]
    v_pk_fma_f32 v[22:23], v[10:11], v[22:23], 1.0 op_sel_hi:[1,1,0]
    v_rcp_f32 v12, v20
    v_rcp_f32 v13, v21
    v_rcp_f32 v14, v22
    v_rcp_f32 v15, v23
    s_nop 0
    v_pk_mul_f32 v[16:17], v[12:13], v[32:33]
    v_pk_mul_f32 v[18:19], v[14:15], v[34:35]
    buffer_load_dwordx4 v[32:35], v[44:45], s[20:23], 0 idxen offen
    s_branch K2F_STEP3
K2F_FLUSH3:
    s_cmp_ge_u32 s44, s43
    s_cbranch_scc1 K2_LAST
    v_cmp_ge_u32 vcc, s44, v53
    s_bcnt1_i32_b64 s47, vcc
    s_sub_u32 s46, s47, 1
    v_readlane_b32 s48, v53, s47
    s_mul_i32 s47, s46, 272
    s_add_u32 s47, s47, s54
    v_add_u32 v52, s47, v54
    ds_read_b128 v[8:11], v52
    s_min_u32 s48, s48, s43
    s_sub_u32 s45, s48, s44
    s_sub_u32 s45, s45, 1
    s_mov_b32 s44, s48
    v_add_u32 v51, s58, v66
    v_permlane32_swap_b32 v12, v16
    v_permlane32_swap_b32 v13, v17
    v_permlane32_swap_b32 v14, v18
    v_permlane32_swap_b32 v15, v19
    v_pk_add_f32 v[12:13], v[12:13], v[16:17]
    v_pk_add_f32 v[14:15], v[14:15], v[18:19]
    s_nop 1
    v_permlane16_swap_b32 v12, v14
    v_permlane16_swap_b32 v13, v15
    v_pk_add_f32 v[16:17], v[12:13], v[14:15]
    ds_write_b64 v51, v[16:17] offset:16896
    s_add_u32 s58, s46, s3
    s_lshl_b32 s58, s58, 9
    v_fma_mix_f32 v20, v49, v4, v36 op_sel:[0,0,0] op_sel_hi:[0,0,1]
    v_fma_mix_f32 v21, v49, v5, v37 op_sel:[0,0,0] op_sel_hi:[0,0,1]
    v_fma_mix_f32 v22, v49, v6, v38 op_sel:[0,0,0] op_sel_hi:[0,0,1]
    v_fma_mix_f32 v23, v49, v7, v39 op_sel:[0,0,0] op_sel_hi:[0,0,1]
    ds_read_u16_d16_hi v48, v50 offset:578
    ds_read_u16 v40, v50 offset:640
    v_exp_f32 v20, v20
    v_exp_f32 v21, v21
    v_exp_f32 v22, v22
    v_exp_f32 v23, v23
    s_waitcnt lgkmcnt(3)
    v_pk_fma_f32 v[20:21], v[8:9], v[20:21], 1.0 op_sel_hi:[1,1,0]
    v_pk_fma_f32 v[22:23], v[10:11], v[22:23], 1.0 op_sel_hi:[1,1,0]
    v_rcp_f32 v12, v20
    v_rcp_f32 v13, v21
    v_rcp_f32 v14, v22
    v_rcp_f32 v15, v23
    s_nop 0
    v_pk_mul_f32 v[16:17], v[12:13], v[36:37]
    v_pk_mul_f32 v[18:19], v[14:15], v[38:39]
    buffer_load_dwordx4 v[36:39], v[46:47], s[20:23], 0 idxen offen
    v_add_u32 v50, 64, v50
    s_sub_u32 s55, s55, 1
    s_cmp_lg_u32 s55, 0
    s_cbranch_scc1 K2F_STEP0
    s_branch K2F_PRIO
K2F_PRIO:
    s_sub_u32 s57, s57, 1
    s_cmp_eq_u32 s57, 2
    s_cbranch_scc1 K2F_PRIO2
    s_cmp_eq_u32 s57, 1
    s_cbranch_scc1 K2F_PRIO1
    s_mov_b32 s55, 0x7fffffff
    s_setprio 0
    s_branch K2F_STEP0
K2F_PRIO2:
    s_mov_b32 s55, s56
    s_setprio 2
    s_branch K2F_STEP0
K2F_PRIO1:
    s_mov_b32 s55, s60
    s_setprio 1
    s_branch K2F_STEP0
K2S_ENTER:
    v_cmp_ge_u32 vcc, s44, v53
    s_bcnt1_i32_b64 s47, vcc
    s_sub_u32 s46, s47, 1
    v_readlane_b32 s48, v53, s47
    s_mul_i32 s47, s46, 272
    s_add_u32 s47, s47, s54
    v_add_u32 v52, s47, v54
    ds_read_b128 v[8:11], v52
    s_min_u32 s48, s48, s43
    s_sub_u32 s45, s48, s44
    s_sub_u32 s45, s45, 1
    s_mov_b32 s44, s48
    s_add_u32 s58, s46, s3
    s_lshl_b32 s58, s58, 9
    s_waitcnt vmcnt(3) lgkmcnt(0)
    v_fma_mix_f32 v20, v48, v4, v24 op_sel:[0,0,0] op_sel_hi:[0,0,1]
    v_fma_mix_f32 v21, v48, v5, v25 op_sel:[0,0,0] op_sel_hi:[0,0,1]
    v_fma_mix_f32 v22, v48, v6, v26 op_sel:[0,0,0] op_sel_hi:[0,0,1]
    v_fma_mix_f32 v23, v48, v7, v27 op_sel:[0,0,0] op_sel_hi:[0,0,1]
    ds_read_u16_d16_hi v49, v50 offset:530
    ds_read_u16 v42, v50 offset:592
    s_waitcnt lgkmcnt(3)
    v_pk_add_f32 v[20:21], v[20:21], v[8:9]
    v_pk_add_f32 v[22:23], v[22:23], v[10:11]
    v_exp_f32 v20, v20
    v_exp_f32 v21, v21
    v_exp_f32 v22, v22
    v_exp_f32 v23, v23
    v_pk_add_f32 v[20:21], v[20:21], 1.0 op_sel_hi:[1,0]
    v_pk_add_f32 v[22:23], v[22:23], 1.0 op_sel_hi:[1,0]
    v_rcp_f32 v12, v20
    v_rcp_f32 v13, v21
    v_rcp_f32 v14, v22
    v_rcp_f32 v15, v23
    s_nop 0
    v_pk_mul_f32 v[16:17], v[12:13], v[24:25]
    v_pk_mul_f32 v[18:19], v[14:15], v[26:27]
    buffer_load_dwordx4 v[24:27], v[40:41], s[20:23], 0 idxen offen
    s_branch K2S_STEP1
K2S_STEP0:
    s_waitcnt vmcnt(3) lgkmcnt(0)
    s_sub_u32 s45, s45, 1
    s_cbranch_scc1 K2S_FLUSH0
    v_fma_mix_f32 v20, v48, v4, v24 op_sel:[0,0,0] op_sel_hi:[0,0,1]
    v_fma_mix_f32 v21, v48, v5, v25 op_sel:[0,0,0] op_sel_hi:[0,0,1]
    v_fma_mix_f32 v22, v48, v6, v26 op_sel:[0,0,0] op_sel_hi:[0,0,1]
    v_fma_mix_f32 v23, v48, v7, v27 op_sel:[0,0,0] op_sel_hi:[0,0,1]
    ds_read_u16_d16_hi v49, v50 offset:530
    ds_read_u16 v42, v50 offset:592
    v_pk_add_f32 v[20:21], v[20:21], v[8:9]
    v_pk_add_f32 v[22:23], v[22:23], v[10:11]
    v_exp_f32 v20, v20
    v_exp_f32 v21, v21
    v_exp_f32 v22, v22
    v_exp_f32 v23, v23
    v_pk_add_f32 v[20:21], v[20:21], 1.0 op_sel_hi:[1,0]
    v_pk_add_f32 v[22:23], v[22:23], 1.0 op_sel_hi:[1,0]
    v_rcp_f32 v20, v20
    v_rcp_f32 v21, v21
    v_rcp_f32 v22, v22
    v_rcp_f32 v23, v23
    v_pk_add_f32 v[12:13], v[12:13], v[20:21]
    v_pk_add_f32 v[14:15], v[14:15], v[22:23]
    v_pk_fma_f32 v[16:17], v[20:21], v[24:25], v[16:17]
    v_pk_fma_f32 v[18:19], v[22:23], v[26:27], v[18:19]
    buffer_load_dwordx4 v[24:27], v[40:41], s[20:23], 0 idxen offen
K2S_STEP1:
    s_waitcnt vmcnt(3) lgkmcnt(0)
    s_sub_u32 s45, s45, 1
    s_cbranch_scc1 K2S_FLUSH1
    v_fma_mix_f32 v20, v49, v4, v28 op_sel:[0,0,0] op_sel_hi:[0,0,1]
    v_fma_mix_f32 v21, v49, v5, v29 op_sel:[0,0,0] op_sel_hi:[0,0,1]
    v_fma_mix_f32 v22, v49, v6, v30 op_sel:[0,0,0] op_sel_hi:[0,0,1]
    v_fma_mix_f32 v23, v49, v7, v31 op_sel:[0,0,0] op_sel_hi:[0,0,1]
    ds_read_u16_d16_hi v48, v50 offset:546
    ds_read_u16 v44, v50 offset:608
    v_pk_add_f32 v[20:21], v[20:21], v[8:9]
    v_pk_add_f32 v[22:23], v[22:23], v[10:11]
    v_exp_f32 v20, v20
    v_exp_f32 v21, v21
    v_exp_f32 v22, v22
    v_exp_f32 v23, v23
    v_pk_add_f32 v[20:21], v[20:21], 1.0 op_sel_hi:[1,0]
    v_pk_add_f32 v[22:23], v[22:23], 1.0 op_sel_hi:[1,0]
    v_rcp_f32 v20, v20
    v_rcp_f32 v21, v21
    v_rcp_f32 v22, v22
    v_rcp_f32 v23, v23
    v_pk_add_f32 v[12:13], v[12:13], v[20:21]
    v_pk_add_f32 v[14:15], v[14:15], v[22:23]
    v_pk_fma_f32 v[16:17], v[20:21], v[28:29], v[16:17]
    v_pk_fma_f32 v[18:19], v[22:23], v[30:31], v[18:19]
    buffer_load_dwordx4 v[28:31], v[42:43], s[20:23], 0 idxen offen
K2S_STEP2:
    s_waitcnt vmcnt(3) lgkmcnt(0)
    s_sub_u32 s45, s45, 1
    s_cbranch_scc1 K2S_FLUSH2
    v_fma_mix_f32 v20, v48, v4, v32 op_sel:[0,0,0] op_sel_hi:[0,0,1]
    v_fma_mix_f32 v21, v48, v5, v33 op_sel:[0,0,0] op_sel_hi:[0,0,1]
    v_fma_mix_f32 v22, v48, v6, v34 op_sel:[0,0,0] op_sel_hi:[0,0,1]
    v_fma_mix_f32 v23, v48, v7, v35 op_sel:[0,0,0] op_sel_hi:[0,0,1]
    ds_read_u16_d16_hi v49, v50 offset:562
    ds_read_u16 v46, v50 offset:624
    v_pk_add_f32 v[20:21], v[20:21], v[8:9]
    v_pk_add_f32 v[22:23], v[22:23], v[10:11]
    v_exp_f32 v20, v20
    v_exp_f32 v21, v21
    v_exp_f32 v22, v22
    v_exp_f32 v23, v23
    v_pk_add_f32 v[20:21], v[20:21], 1.0 op_sel_hi:[1,0]
    v_pk_add_f32 v[22:23], v[22:23], 1.0 op_sel_hi:[1,0]
    v_rcp_f32 v20, v20
    v_rcp_f32 v21, v21
    v_rcp_f32 v22, v22
    v_rcp_f32 v23, v23
    v_pk_add_f32 v[12:13], v[12:13], v[20:21]
    v_pk_add_f32 v[14:15], v[14:15], v[22:23]
    v_pk_fma_f32 v[16:17], v[20:21], v[32:33], v[16:17]
    v_pk_fma_f32 v[18:19], v[22:23], v[34:35], v[18:19]
    buffer_load_dwordx4 v[32:35], v[44:45], s[20:23], 0 idxen offen
K2S_STEP3:
    s_waitcnt vmcnt(3) lgkmcnt(0)
    s_sub_u32 s45, s45, 1
    s_cbranch_scc1 K2S_FLUSH3
    v_fma_mix_f32 v20, v49, v4, v36 op_sel:[0,0,0] op_sel_hi:[0,0,1]
    v_fma_mix_f32 v21, v49, v5, v37 op_sel:[0,0,0] op_sel_hi:[0,0,1]
    v_fma_mix_f32 v22, v49, v6, v38 op_sel:[0,0,0] op_sel_hi:[0,0,1]
    v_fma_mix_f32 v23, v49, v7, v39 op_sel:[0,0,0] op_sel_hi:[0,0,1]
    ds_read_u16_d16_hi v48, v50 offset:578
    ds_read_u16 v40, v50 offset:640
    v_pk_add_f32 v[20:21], v[20:21], v[8:9]
    v_pk_add_f32 v[22:23], v[22:23], v[10:11]
    v_exp_f32 v20, v20
    v_exp_f32 v21, v21
    v_exp_f32 v22, v22
    v_exp_f32 v23, v23
    v_pk_add_f32 v[20:21], v[20:21], 1.0 op_sel_hi:[1,0]
    v_pk_add_f32 v[22:23], v[22:23], 1.0 op_sel_hi:[1,0]
    v_rcp_f32 v20, v20
    v_rcp_f32 v21, v21
    v_rcp_f32 v22, v22
    v_rcp_f32 v23, v23
    v_pk_add_f32 v[12:13], v[12:13], v[20:21]
    v_pk_add_f32 v[14:15], v[14:15], v[22:23]
    v_pk_fma_f32 v[16:17], v[20:21], v[36:37], v[16:17]
    v_pk_fma_f32 v[18:19], v[22:23], v[38:39], v[18:19]
    buffer_load_dwordx4 v[36:39], v[46:47], s[20:23], 0 idxen offen
    v_add_u32 v50, 64, v50
    s_sub_u32 s55, s55, 1
    s_cmp_lg_u32 s55, 0
    s_cbranch_scc1 K2S_STEP0
    s_branch K2S_PRIO
K2S_FLUSH0:
    s_cmp_ge_u32 s44, s43
    s_cbranch_scc1 K2_LAST
    v_cmp_ge_u32 vcc, s44, v53
    s_bcnt1_i32_b64 s47, vcc
    s_sub_u32 s46, s47, 1
    v_readlane_b32 s48, v53, s47
    s_mul_i32 s47, s46, 272
    s_add_u32 s47, s47, s54
    v_add_u32 v52, s47, v54
    ds_read_b128 v[8:11], v52
    s_min_u32 s48, s48, s43
    s_sub_u32 s45, s48, s44
    s_sub_u32 s45, s45, 1
    s_mov_b32 s44, s48
    v_add_u32 v51, s58, v66
    v_permlane32_swap_b32 v12, v16
    v_permlane32_swap_b32 v13, v17
    v_permlane32_swap_b32 v14, v18
    v_permlane32_swap_b32 v15, v19
    v_pk_add_f32 v[12:13], v[12:13], v[16:17]
    v_pk_add_f32 v[14:15], v[14:15], v[18:19]
    s_nop 1
    v_permlane16_swap_b32 v12, v14
    v_permlane16_swap_b32 v13, v15
    v_pk_add_f32 v[16:17], v[12:13], v[14:15]
    ds_write_b64 v51, v[16:17] offset:16896
    s_add_u32 s58, s46, s3
    s_lshl_b32 s58, s58, 9
    v_fma_mix_f32 v20, v48, v4, v24 op_sel:[0,0,0] op_sel_hi:[0,0,1]
    v_fma_mix_f32 v21, v48, v5, v25 op_sel:[0,0,0] op_sel_hi:[0,0,1]
    v_fma_mix_f32 v22, v48, v6, v26 op_sel:[0,0,0] op_sel_hi:[0,0,1]
    v_fma_mix_f32 v23, v48, v7, v27 op_sel:[0,0,0] op_sel_hi:[0,0,1]
    ds_read_u16_d16_hi v49, v50 offset:530
    ds_read_u16 v42, v50 offset:592
    s_waitcnt lgkmcnt(3)
    v_pk_add_f32 v[20:21], v[20:21], v[8:9]
    v_pk_add_f32 v[22:23], v[22:23], v[10:11]
    v_exp_f32 v20, v20
    v_exp_f32 v21, v21
    v_exp_f32 v22, v22
    v_exp_f32 v23, v23
    v_pk_add_f32 v[20:21], v[20:21], 1.0 op_sel_hi:[1,0]
    v_pk_add_f32 v[22:23], v[22:23], 1.0 op_sel_hi:[1,0]
    v_rcp_f32 v12, v20
    v_rcp_f32 v13, v21
    v_rcp_f32 v14, v22
    v_rcp_f32 v15, v23
    s_nop 0
    v_pk_mul_f32 v[16:17], v[12:13], v[24:25]
    v_pk_mul_f32 v[18:19], v[14:15], v[26:27]
    buffer_load_dwordx4 v[24:27], v[40:41], s[20:23], 0 idxen offen
    s_branch K2S_STEP1
K2S_FLUSH1:
    s_cmp_ge_u32 s44, s43
    s_cbranch_scc1 K2_LAST
    v_cmp_ge_u32 vcc, s44, v53
    s_bcnt1_i32_b64 s47, vcc
    s_sub_u32 s46, s47, 1
    v_readlane_b32 s48, v53, s47
    s_mul_i32 s47, s46, 272
    s_add_u32 s47, s47, s54
    v_add_u32 v52, s47, v54
    ds_read_b128 v[8:11], v52
    s_min_u32 s48, s48, s43
    s_sub_u32 s45, s48, s44
    s_sub_u32 s45, s45, 1
    s_mov_b32 s44, s48
    v_add_u32 v51, s58, v66
    v_permlane32_swap_b32 v12, v16
    v_permlane32_swap_b32 v13, v17
    v_permlane32_swap_b32 v14, v18
    v_permlane32_swap_b32 v15, v19
    v_pk_add_f32 v[12:13], v[12:13], v[16:17]
    v_pk_add_f32 v[14:15], v[14:15], v[18:19]
    s_nop 1
    v_permlane16_swap_b32 v12, v14
    v_permlane16_swap_b32 v13, v15
    v_pk_add_f32 v[16:17], v[12:13], v[14:15]
    ds_write_b64 v51, v[16:17] offset:16896
    s_add_u32 s58, s46, s3
    s_lshl_b32 s58, s58, 9
    v_fma_mix_f32 v20, v49, v4, v28 op_sel:[0,0,0] op_sel_hi:[0,0,1]
    v_fma_mix_f32 v21, v49, v5, v29 op_sel:[0,0,0] op_sel_hi:[0,0,1]
    v_fma_mix_f32 v22, v49, v6, v30 op_sel:[0,0,0] op_sel_hi:[0,0,1]
    v_fma_mix_f32 v23, v49, v7, v31 op_sel:[0,0,0] op_sel_hi:[0,0,1]
    ds_read_u16_d16_hi v48, v50 offset:546
    ds_read_u16 v44, v50 offset:608
    s_waitcnt lgkmcnt(3)
    v_pk_add_f32 v[20:21], v[20:21], v[8:9]
    v_pk_add_f32 v[22:23], v[22:23], v[10:11]
    v_exp_f32 v20, v20
    v_exp_f32 v21, v21
    v_exp_f32 v22, v22
    v_exp_f32 v23, v23
    v_pk_add_f32 v[20:21], v[20:21], 1.0 op_sel_hi:[1,0]
    v_pk_add_f32 v[22:23], v[22:23], 1.0 op_sel_hi:[1,0]
    v_rcp_f32 v12, v20
    v_rcp_f32 v13, v21
    v_rcp_f32 v14, v22
    v_rcp_f32 v15, v23
    s_nop 0
    v_pk_mul_f32 v[16:17], v[12:13], v[28:29]
    v_pk_mul_f32 v[18:19], v[14:15], v[30:31]
    buffer_load_dwordx4 v[28:31], v[42:43], s[20:23], 0 idxen offen
    s_branch K2S_STEP2
K2S_FLUSH2:
    s_cmp_ge_u32 s44, s43
    s_cbranch_scc1 K2_LAST
    v_cmp_ge_u32 vcc, s44, v53
    s_bcnt1_i32_b64 s47, vcc
    s_sub_u32 s46, s47, 1
    v_readlane_b32 s48, v53, s47
    s_mul_i32 s47, s46, 272
    s_add_u32 s47, s47, s54
    v_add_u32 v52, s47, v54
    ds_read_b128 v[8:11], v52
    s_min_u32 s48, s48, s43
    s_sub_u32 s45, s48, s44
    s_sub_u32 s45, s45, 1
    s_mov_b32 s44, s48
    v_add_u32 v51, s58, v66
    v_permlane32_swap_b32 v12, v16
    v_permlane32_swap_b32 v13, v17
    v_permlane32_swap_b32 v14, v18
    v_permlane32_swap_b32 v15, v19
    v_pk_add_f32 v[12:13], v[12:13], v[16:17]
    v_pk_add_f32 v[14:15], v[14:15], v[18:19]
    s_nop 1
    v_permlane16_swap_b32 v12, v14
    v_permlane16_swap_b32 v13, v15
    v_pk_add_f32 v[16:17], v[12:13], v[14:15]
    ds_write_b64 v51, v[16:17] offset:16896
    s_add_u32 s58, s46, s3
    s_lshl_b32 s58, s58, 9
    v_fma_mix_f32 v20, v48, v4, v32 op_sel:[0,0,0] op_sel_hi:[0,0,1]
    v_fma_mix_f32 v21, v48, v5, v33 op_sel:[0,0,0] op_sel_hi:[0,0,1]
    v_fma_mix_f32 v22, v48, v6, v34 op_sel:[0,0,0] op_sel_hi:[0,0,1]
    v_fma_mix_f32 v23, v48, v7, v35 op_sel:[0,0,0] op_sel_hi:[0,0,1]
    ds_read_u16_d16_hi v49, v50 offset:562
    ds_read_u16 v46, v50 offset:624
    s_waitcnt lgkmcnt(3)
    v_pk_add_f32 v[20:21], v[20:21], v[8:9]
    v_pk_add_f32 v[22:23], v[22:23], v[10:11]
    v_exp_f32 v20, v20
    v_exp_f32 v21, v21
    v_exp_f32 v22, v22
    v_exp_f32 v23, v23
    v_pk_add_f32 v[20:21], v[20:21], 1.0 op_sel_hi:[1,0]
    v_pk_add_f32 v[22:23], v[22:23], 1.0 op_sel_hi:[1,0]
    v_rcp_f32 v12, v20
    v_rcp_f32 v13, v21
    v_rcp_f32 v14, v22
    v_rcp_f32 v15, v23
    s_nop 0
    v_pk_mul_f32 v[16:17], v[12:13], v[32:33]
    v_pk_mul_f32 v[18:19], v[14:15], v[34:35]
    buffer_load_dwordx4 v[32:35], v[44:45], s[20:23], 0 idxen offen
    s_branch K2S_STEP3
K2S_FLUSH3:
    s_cmp_ge_u32 s44, s43
    s_cbranch_scc1 K2_LAST
    v_cmp_ge_u32 vcc, s44, v53
    s_bcnt1_i32_b64 s47, vcc
    s_sub_u32 s46, s47, 1
    v_readlane_b32 s48, v53, s47
    s_mul_i32 s47, s46, 272
    s_add_u32 s47, s47, s54
    v_add_u32 v52, s47, v54
    ds_read_b128 v[8:11], v52
    s_min_u32 s48, s48, s43
    s_sub_u32 s45, s48, s44
    s_sub_u32 s45, s45, 1
    s_mov_b32 s44, s48
    v_add_u32 v51, s58, v66
    v_permlane32_swap_b32 v12, v16
    v_permlane32_swap_b32 v13, v17
    v_permlane32_swap_b32 v14, v18
    v_permlane32_swap_b32 v15, v19
    v_pk_add_f32 v[12:13], v[12:13], v[16:17]
    v_pk_add_f32 v[14:15], v[14:15], v[18:19]
    s_nop 1
    v_permlane16_swap_b32 v12, v14
    v_permlane16_swap_b32 v13, v15
    v_pk_add_f32 v[16:17], v[12:13], v[14:15]
    ds_write_b64 v51, v[16:17] offset:16896
    s_add_u32 s58, s46, s3
    s_lshl_b32 s58, s58, 9
    v_fma_mix_f32 v20, v49, v4, v36 op_sel:[0,0,0] op_sel_hi:[0,0,1]
    v_fma_mix_f32 v21, v49, v5, v37 op_sel:[0,0,0] op_sel_hi:[0,0,1]
    v_fma_mix_f32 v22, v49, v6, v38 op_sel:[0,0,0] op_sel_hi:[0,0,1]
    v_fma_mix_f32 v23, v49, v7, v39 op_sel:[0,0,0] op_sel_hi:[0,0,1]
    ds_read_u16_d16_hi v48, v50 offset:578
    ds_read_u16 v40, v50 offset:640
    s_waitcnt lgkmcnt(3)
    v_pk_add_f32 v[20:21], v[20:21], v[8:9]
    v_pk_add_f32 v[22:23], v[22:23], v[10:11]
    v_exp_f32 v20, v20
    v_exp_f32 v21, v21
    v_exp_f32 v22, v22
    v_exp_f32 v23, v23
    v_pk_add_f32 v[20:21], v[20:21], 1.0 op_sel_hi:[1,0]
    v_pk_add_f32 v[22:23], v[22:23], 1.0 op_sel_hi:[1,0]
    v_rcp_f32 v12, v20
    v_rcp_f32 v13, v21
    v_rcp_f32 v14, v22
    v_rcp_f32 v15, v23
    s_nop 0
    v_pk_mul_f32 v[16:17], v[12:13], v[36:37]
    v_pk_mul_f32 v[18:19], v[14:15], v[38:39]
    buffer_load_dwordx4 v[36:39], v[46:47], s[20:23], 0 idxen offen
    v_add_u32 v50, 64, v50
    s_sub_u32 s55, s55, 1
    s_cmp_lg_u32 s55, 0
    s_cbranch_scc1 K2S_STEP0
    s_branch K2S_PRIO
K2S_PRIO:
    s_sub_u32 s57, s57, 1
    s_cmp_eq_u32 s57, 2
    s_cbranch_scc1 K2S_PRIO2
    s_cmp_eq_u32 s57, 1
    s_cbranch_scc1 K2S_PRIO1
    s_mov_b32 s55, 0x7fffffff
    s_setprio 0
    s_branch K2S_STEP0
K2S_PRIO2:
    s_mov_b32 s55, s56
    s_setprio 2
    s_branch K2S_STEP0
K2S_PRIO1:
    s_mov_b32 s55, s60
    s_setprio 1
    s_branch K2S_STEP0
K2_LAST:
    v_add_u32 v51, s58, v66
    v_permlane32_swap_b32 v12, v16
    v_permlane32_swap_b32 v13, v17
    v_permlane32_swap_b32 v14, v18
    v_permlane32_swap_b32 v15, v19
    v_pk_add_f32 v[12:13], v[12:13], v[16:17]
    v_pk_add_f32 v[14:15], v[14:15], v[18:19]
    s_nop 1
    v_permlane16_swap_b32 v12, v14
    v_permlane16_swap_b32 v13, v15
    v_pk_add_f32 v[16:17], v[12:13], v[14:15]
    ds_write_b64 v51, v[16:17] offset:16896
K2_MAIN_DONE:
    s_setprio 0
    s_cmp_eq_u32 s41, 0
    s_cbranch_scc0 K2_NOUST
    s_cmp_eq_u32 s40, 1
    s_cbranch_scc1 K2_NOUST
    s_cmp_lt_u32 s3, 12
    s_cbranch_scc0 K2_NOUST
    ds_write_b128 v100, v[96:99] offset:13056
K2_NOUST:
    s_cmp_eq_u32 s40, 2
    s_cbranch_scc0 K2_NOABORT
    s_mov_b32 s40, 1
    s_mov_b32 s41, 0
    s_waitcnt vmcnt(0) lgkmcnt(0)
    s_barrier
    s_branch K2_PASS
K2_NOABORT:
    s_waitcnt lgkmcnt(0)
    s_barrier
    s_cmp_lt_u32 s3, 10
    s_cbranch_scc0 K2_FOLD_END
    s_mov_b64 exec, s[64:65]
    ds_read_b128 v[76:79], v101 offset:16896
    ds_read_b128 v[80:83], v101 offset:17152
    s_mov_b64 exec, s[66:67]
    ds_read_b128 v[84:87], v101 offset:17408
    ds_read_b128 v[88:91], v101 offset:17664
    s_mov_b64 exec, -1
    ds_read_b128 v[92:95], v103
    ds_read_b64 v[104:105], v106
    s_mov_b64 exec, s[64:65]
    s_waitcnt lgkmcnt(4)
    v_pk_add_f32 v[56:57], v[56:57], v[76:77]
    v_pk_add_f32 v[58:59], v[58:59], v[78:79]
    v_pk_add_f32 v[60:61], v[60:61], v[80:81]
    v_pk_add_f32 v[62:63], v[62:63], v[82:83]
    s_mov_b64 exec, s[66:67]
    s_waitcnt lgkmcnt(2)
    v_pk_add_f32 v[56:57], v[56:57], v[84:85]
    v_pk_add_f32 v[58:59], v[58:59], v[86:87]
    v_pk_add_f32 v[60:61], v[60:61], v[88:89]
    v_pk_add_f32 v[62:63], v[62:63], v[90:91]
    s_mov_b64 exec, -1
    s_cmp_eq_u64 s[68:69], 0
    s_cbranch_scc1 K2_FOLD_END
    v_add_u32 v101, 1024, v101
    v_add_u32 v102, -2, v102
K2_FOLD:
    v_cmp_lt_i32 vcc, 0, v102
    s_and_saveexec_b64 s[52:53], vcc
    s_cbranch_execz K2_FOLD_DONE
    ds_read_b128 v[76:79], v101 offset:16896
    ds_read_b128 v[80:83], v101 offset:17152
    v_add_u32 v101, 512, v101
    v_add_u32 v102, -1, v102
    s_waitcnt lgkmcnt(0)
    v_pk_add_f32 v[56:57], v[56:57], v[76:77]
    v_pk_add_f32 v[58:59], v[58:59], v[78:79]
    v_pk_add_f32 v[60:61], v[60:61], v[80:81]
    v_pk_add_f32 v[62:63], v[62:63], v[82:83]
    s_mov_b64 exec, s[52:53]
    s_branch K2_FOLD
K2_FOLD_DONE:
    s_mov_b64 exec, s[52:53]
K2_FOLD_END:
    s_cmp_eq_u32 s40, 0
    s_cbranch_scc1 K2_EPI
    s_add_u32 s41, s41, 1
    s_cmp_lt_u32 s41, 256
    s_cbranch_scc0 K2_EPI
    s_waitcnt vmcnt(0) lgkmcnt(0)
    s_barrier
    s_branch K2_PASS
K2_EPI:
    v_cmp_gt_u32 vcc, s61, v0
    s_and_saveexec_b64 s[52:53], vcc
    s_cbranch_execz K2_FIN
    s_mov_b32 s47, 0x358637bd
    v_add_f32 v56, s47, v56
    v_add_f32 v57, s47, v57
    v_add_f32 v58, s47, v58
    v_add_f32 v59, s47, v59
    v_rcp_f32 v56, v56
    v_rcp_f32 v57, v57
    v_rcp_f32 v58, v58
    v_rcp_f32 v59, v59
    s_waitcnt lgkmcnt(0)
    v_lshlrev_b32 v20, 16, v104
    v_and_b32 v21, 0xffff0000, v104
    v_lshlrev_b32 v22, 16, v105
    v_and_b32 v23, 0xffff0000, v105
    v_fma_f32 v60, v60, v56, v92
    v_fma_f32 v61, v61, v57, v93
    v_fma_f32 v62, v62, v58, v94
    v_fma_f32 v63, v63, v59, v95
    v_cmp_lt_f32 s[64:65], 0, v60
    v_cmp_lt_f32 s[66:67], 0, v61
    v_cmp_lt_f32 s[68:69], 0, v62
    v_cmp_lt_f32 s[70:71], 0, v63
    v_mul_f32 v12, 0, v60
    v_mul_f32 v13, 0, v61
    v_mul_f32 v14, 0, v62
    v_mul_f32 v15, 0, v63
    v_cndmask_b32 v60, v12, v60, s[64:65]
    v_cndmask_b32 v61, v13, v61, s[66:67]
    v_cndmask_b32 v62, v14, v62, s[68:69]
    v_cndmask_b32 v63, v15, v63, s[70:71]
    v_add_f32 v60, v60, v20
    v_add_f32 v61, v61, v21
    v_add_f32 v62, v62, v22
    v_add_f32 v63, v63, v23
    s_lshl_b32 s48, s62, 7
    v_lshlrev_b32 v109, 3, v0
    v_cvt_pk_bf16_f32 v12, v60, v61
    v_cvt_pk_bf16_f32 v13, v62, v63
    buffer_store_dwordx2 v[12:13], v109, s[32:35], s48 offen sc1
K2_FIN:
K2_END:
    s_endpgm
CODE_END:
.section .rodata,"a"
.p2align 6
.amdhsa_kernel k1_kernel
  .amdhsa_next_free_vgpr 96
  .amdhsa_next_free_sgpr 72
  .amdhsa_accum_offset 96
  .amdhsa_group_segment_fixed_size 0
  .amdhsa_kernarg_size 96
  .amdhsa_user_sgpr_count 2
  .amdhsa_user_sgpr_kernarg_segment_ptr 1
  .amdhsa_system_sgpr_workgroup_id_x 1
  .amdhsa_float_denorm_mode_32 3
.end_amdhsa_kernel
.p2align 6
.amdhsa_kernel k2_kernel
  .amdhsa_next_free_vgpr 128
  .amdhsa_next_free_sgpr 80
  .amdhsa_accum_offset 128
  .amdhsa_group_segment_fixed_size 0
  .amdhsa_kernarg_size 96
  .amdhsa_user_sgpr_count 2
  .amdhsa_user_sgpr_kernarg_segment_ptr 1
  .amdhsa_system_sgpr_workgroup_id_x 1
  .amdhsa_float_denorm_mode_32 3
.end_amdhsa_kernel
```
